```python
import torch

def _softmax(x, axis=-1):
    return torch.softmax(x, dim=axis)
def _gelu(x):
    return torch.nn.functional.gelu(x, approximate="tanh")
def _silu(x):
    return torch.nn.functional.silu(x)
def _sigmoid(x):
    return torch.sigmoid(x)
def _layernorm(x, axis=-1, eps=1e-5):
    m = x.mean(dim=axis, keepdim=True)
    v = x.var(dim=axis, keepdim=True, unbiased=False)
    return (x - m) / torch.sqrt(v + eps)
def _scatter_add(tgt, idx, src, axis=0):
    return tgt.clone().index_add_(axis, idx, src)
def _segment_sum(src, seg, n):
    out = torch.zeros((n,) + src.shape[1:], dtype=src.dtype)
    return out.index_add_(0, seg, src)
def _pad(x, pw):
    flat = tuple(v for pair in reversed(pw) for v in pair)
    return torch.nn.functional.pad(x, flat)

kernel_name = 'gated_mix__ssm_conv_s5__glu_gated_bilinear__prompt'

def setup_inputs():

    _w = (lambda a: (lambda t: t.to(torch.bfloat16) if t.is_floating_point() else t)(torch.as_tensor(a)))
    def _A_setup():
        B, S, D = 1, 2048, 448
        P = D
        Lambda_re = -0.5 * (lambda _x: torch.exp(torch.as_tensor(_x)))((lambda *s: torch.randn(*s, dtype=torch.bfloat16) * 0.2)(P))
        Lambda_im = (lambda *s: torch.randn(*s, dtype=torch.bfloat16) * 0.4)(P) * 1.0
        B_re = (lambda *s: torch.randn(*s, dtype=torch.bfloat16) * 0.2)(P, D) * (D ** -0.5)
        B_im = (lambda *s: torch.randn(*s, dtype=torch.bfloat16) * 0.2)(P, D) * (D ** -0.5)
        C_re = (lambda *s: torch.randn(*s, dtype=torch.bfloat16) * 0.2)(D, P) * (P ** -0.5)
        C_im = (lambda *s: torch.randn(*s, dtype=torch.bfloat16) * 0.2)(D, P) * (P ** -0.5)
        log_dt = (lambda *s: torch.randn(*s, dtype=torch.bfloat16) * 0.2)(P) * 0.3 - 2.0
        Dskip = (lambda *s: torch.randn(*s, dtype=torch.bfloat16) * 0.05)(D)
        return {
            "x": _w((lambda *s: torch.randn(*s, dtype=torch.bfloat16) * 0.05)(B, S, D)),
            "Lambda_re": _w(Lambda_re),
            "Lambda_im": _w(Lambda_im),
            "B_re": _w(B_re),
            "B_im": _w(B_im),
            "C_re": _w(C_re),
            "C_im": _w(C_im),
            "log_dt": _w(log_dt),
            "Dskip": _w(Dskip),
        }
    _A_in = _A_setup()

    def _B_setup():
        B, S, D, F = 1, 2048, 448, 1792
        return {
            "x": _w((lambda *s: torch.randn(*s, dtype=torch.bfloat16) * 0.05)(B, S, D)),
            "w_gate": _w((lambda *s: torch.randn(*s, dtype=torch.bfloat16) * 0.8)(D, F) * (D ** -0.5)),
            "w_up": _w((lambda *s: torch.randn(*s, dtype=torch.bfloat16) * 0.8)(D, F) * (D ** -0.5)),
            "w_down": _w((lambda *s: torch.randn(*s, dtype=torch.bfloat16) * 0.8)(F, D) * (F ** -0.5)),
        }
    _B_in = _B_setup()

    return {
        "A_x": _A_in["x"],
        "A_Lambda_re": _A_in["Lambda_re"],
        "A_Lambda_im": _A_in["Lambda_im"],
        "A_B_re": _A_in["B_re"],
        "A_B_im": _A_in["B_im"],
        "A_C_re": _A_in["C_re"],
        "A_C_im": _A_in["C_im"],
        "A_log_dt": _A_in["log_dt"],
        "A_Dskip": _A_in["Dskip"],
        "B_x": _B_in["x"],
        "B_w_gate": _B_in["w_gate"],
        "B_w_up": _B_in["w_up"],
        "B_w_down": _B_in["w_down"],
        "gate_w": _w((lambda *s: torch.randn(*s, dtype=torch.bfloat16) * 0.05)(448) * 16.0),
    }

def reference(A_x, A_Lambda_re, A_Lambda_im, A_B_re, A_B_im, A_C_re, A_C_im, A_log_dt, A_Dskip, B_x, B_w_gate, B_w_up, B_w_down, gate_w):
    def _A_ref(x, Lambda_re, Lambda_im, B_re, B_im, C_re, C_im, log_dt, Dskip):
        Bsz, L, H = x.shape
        Lam = Lambda_re + 1j * Lambda_im
        Bmat = B_re + 1j * B_im
        Cmat = C_re + 1j * C_im
        dt = torch.exp(log_dt)
        Lam_bar = torch.exp(dt * Lam)
        B_bar = ((Lam_bar - 1.0) / Lam)[:, None] * Bmat
        Bu = torch.einsum("bld,pd->blp", x + 0j, B_bar)
        h = torch.zeros_like(Bu[:, 0, :])
        hs = []
        for t in range(L):
            h = Lam_bar[None, :] * h + Bu[:, t, :]
            hs.append(h)
        hseq = torch.stack(hs, 1)
        y = 2.0 * torch.einsum("blp,dp->bld", hseq, Cmat).real + x * Dskip[None, None, :]
        return y

    def _B_ref(x, w_gate, w_up, w_down):
        g = torch.einsum("bsd,df->bsf", x, w_gate)
        u = torch.einsum("bsd,df->bsf", x, w_up)
        h = g * u
        return torch.einsum("bsf,fd->bsd", h, w_down)

    x = A_x
    g = _sigmoid((x * gate_w).sum(-1, keepdims=True))
    a = _A_ref(x, A_Lambda_re, A_Lambda_im, A_B_re, A_B_im, A_C_re, A_C_im, A_log_dt, A_Dskip)
    b = _B_ref(x, B_w_gate, B_w_up, B_w_down)
    return g * a + (1 - g) * b
```

```asm
; @launch grid=(256,1,1) block=(256,1,1) lds=163840
.amdgcn_target "amdgcn-amd-amdhsa--gfx950"
.text
.globl gated_mix__ssm_conv_s5__glu_gated_bilinear__prompt_kernel
.p2align 8
.type gated_mix__ssm_conv_s5__glu_gated_bilinear__prompt_kernel,@function
gated_mix__ssm_conv_s5__glu_gated_bilinear__prompt_kernel:
    s_load_dwordx16 s[4:19], s[0:1], 0
    s_load_dwordx16 s[20:35], s[0:1], 64
    s_load_dwordx2 s[36:37], s[0:1], 128
    v_lshrrev_b32 v2, 6, v0
    v_and_b32 v1, 63, v0
    s_lshr_b32 s61, s2, 3
    v_readfirstlane_b32 s3, v2
    s_cmp_ge_u32 s61, 28
    s_mov_b32 s43, 0x20000
    s_mov_b32 s42, 1835008
    s_cbranch_scc0 L_main
    s_cmp_ge_u32 s61, 32
    s_cbranch_scc1 L_end
    s_getpc_b64 s[64:65]
L_pc:
    s_sub_u32 s73, s61, 28
    s_lshl_b32 s67, s73, 12
    s_sub_u32 s64, s64, L_pc-gated_mix__ssm_conv_s5__glu_gated_bilinear__prompt_kernel
    s_subb_u32 s65, s65, 0
    v_lshl_add_u32 v2, v0, 4, s67
    global_load_dwordx4 v[252:255], v2, s[64:65]
    v_add_u32 v2, 16384, v2
    s_cmp_ge_u32 s73, 4
    s_cbranch_scc1 L_spare
    global_load_dwordx4 v[252:255], v2, s[64:65]
    v_add_u32 v2, 16384, v2
    s_cmp_ge_u32 s73, 1
    s_cbranch_scc1 L_spare
    global_load_dwordx4 v[252:255], v2, s[64:65]
    s_branch L_spare
L_main:
    s_and_b32 s60, s2, 7
    s_and_b32 s63, s61, 3
    s_lshr_b32 s68, s61, 2
    s_and_b32 s96, s2, 1
    s_lshl2_add_u32 s96, s96, s63
    s_lshr_b32 s93, s60, 1
    s_mul_i32 s62, s93, 7
    s_add_u32 s62, s62, s68
    s_lshl_b32 s86, s3, 12
    s_lshl2_add_u32 s87, s96, s3
    s_mul_i32 s88, s87, 57344
    s_and_b32 s90, s3, 1
    s_mul_i32 s89, s90, 114688
    s_lshl_b32 s94, s62, 5
    s_lshl2_add_u32 s89, s94, s89
    s_add_u32 s92, s63, s68
    s_lshl_b32 s92, s92, 2
    s_and_b32 s92, s92, 12
    s_lshr_b32 s92, 4112, s92
    s_and_b32 s92, s92, 7
    s_lshl_b32 s93, s60, 2
    s_lshr_b32 s97, 808464432, s93
    s_and_b32 s97, s97, 7
    s_add_u32 s92, s92, s97
    s_sub_u32 s93, s92, 7
    s_cselect_b32 s92, s92, s93
    s_lshl_b32 s72, s92, 7
    s_mul_i32 s79, s72, 1792
    v_lshrrev_b32 v2, 3, v1
    v_and_b32 v3, 7, v1
    v_lshrrev_b32 v4, 4, v1
    v_xor_b32 v5, v3, v4
    v_lshrrev_b32 v6, 1, v1
    v_and_b32 v6, 16, v6
    v_and_or_b32 v6, v2, 3, v6
    v_mul_u32_u24 v6, 896, v6
    v_lshl_add_u32 v10, v5, 4, v6
    v_xor_b32 v7, 64, v10
    v_add_u32 v11, 27648, v7
    v_add_u32 v12, 1536, v10
    v_add_u32 v13, 29184, v7
    v_and_b32 v7, 2, v2
    v_xor_b32 v7, v3, v7
    v_mul_u32_u24 v6, 3584, v2
    v_lshl_add_u32 v14, v7, 4, v6
    v_xor_b32 v7, 64, v14
    v_add_u32 v15, 27648, v7
    v_add_u32 v16, 55296, v14
    v_add_u32 v17, 82944, v7
    v_and_b32 v9, 14, v1
    v_lshl_add_u32 v9, v9, 1, s94
    v_mov_b32 v8, 0
    s_mov_b32 s51, s43
    s_mov_b32 s50, 1605632
    s_add_u32 m0, s86, 114688
    s_waitcnt lgkmcnt(0)
    s_add_u32 s40, s4, s88
    s_addc_u32 s41, s5, 0
    buffer_load_dwordx4 v10, s[40:43], s72 offen offset:0 lds
    buffer_load_dwordx4 v11, s[40:43], s72 offen offset:1024 lds
    buffer_load_dwordx4 v12, s[40:43], s72 offen offset:2048 lds
    buffer_load_dwordx4 v13, s[40:43], s72 offen offset:3072 lds
    s_cmp_lt_u32 s3, 2
    s_cselect_b64 s[48:49], s[24:25], s[26:27]
    s_cselect_b64 s[44:45], s[10:11], s[12:13]
    s_add_u32 s48, s48, s89
    s_addc_u32 s49, s49, 0
    s_add_u32 m0, s86, 0
    global_load_dword v37, v8, s[36:37] sc1
    global_load_dword v55, v9, s[6:7]
    global_load_dword v56, v9, s[8:9]
    global_load_dword v57, v9, s[18:19]
    buffer_load_dwordx4 v14, s[48:51], s79 offen offset:0 lds
    buffer_load_dwordx4 v15, s[48:51], s79 offen offset:1024 lds
    v_mul_u32_u24 v6, 896, v2
    v_lshl_add_u32 v18, v5, 4, v6
    s_lshl_b32 s93, s90, 6
    v_xor_b32 v18, s93, v18
    v_lshlrev_b32 v7, 1, v4
    v_xor_b32 v7, v3, v7
    v_lshl_add_u32 v19, v7, 4, v6
    v_add_u32 v20, 6144, v19
    v_add_u32 v21, 12288, v19
    v_add_u32 v22, 18432, v19
    v_lshlrev_b32 v23, 4, v1
    s_lshl1_add_u32 s92, s62, s90
    s_mul_i32 s92, s92, 7168
    s_add_u32 s44, s44, s92
    s_addc_u32 s45, s45, 0
    s_mov_b32 s47, 0x20000
    s_mov_b32 s46, 401408
    s_lshl_b32 s1, s3, 10
    s_add_u32 s93, s61, s68
    s_bitcmp1_b32 s93, 0
    s_cselect_b32 s92, 4294045681, 0
    s_cselect_b32 s95, 15725025, 0
    s_add_u32 s92, s92, 106119696
    s_add_u32 s95, s95, 90452256
    s_bitcmp1_b32 s93, 1
    s_cselect_b32 s92, s95, s92
    s_bfe_u32 s73, s92, 262148
    s_add_u32 s73, s73, s97
    s_sub_u32 s93, s73, 7
    s_cselect_b32 s73, s73, s93
    s_lshl_b32 s73, s73, 7
    s_mul_i32 s80, s73, 1792
    s_bfe_u32 s74, s92, 262152
    s_add_u32 s74, s74, s97
    s_sub_u32 s93, s74, 7
    s_cselect_b32 s74, s74, s93
    s_lshl_b32 s74, s74, 7
    s_mul_i32 s81, s74, 1792
    s_bfe_u32 s75, s92, 262156
    s_add_u32 s75, s75, s97
    s_sub_u32 s93, s75, 7
    s_cselect_b32 s75, s75, s93
    s_lshl_b32 s75, s75, 7
    s_mul_i32 s82, s75, 1792
    s_bfe_u32 s76, s92, 262160
    s_add_u32 s76, s76, s97
    s_sub_u32 s93, s76, 7
    s_cselect_b32 s76, s76, s93
    s_lshl_b32 s76, s76, 7
    s_mul_i32 s83, s76, 1792
    s_bfe_u32 s77, s92, 262164
    s_add_u32 s77, s77, s97
    s_sub_u32 s93, s77, 7
    s_cselect_b32 s77, s77, s93
    s_lshl_b32 s77, s77, 7
    s_mul_i32 s84, s77, 1792
    s_bfe_u32 s78, s92, 262168
    s_add_u32 s78, s78, s97
    s_sub_u32 s93, s78, 7
    s_cselect_b32 s78, s78, s93
    s_lshl_b32 s78, s78, 7
    s_mul_i32 s85, s78, 1792
    v_and_b32 v2, 15, v1
    v_lshrrev_b32 v3, 4, v1
    v_lshrrev_b32 v5, 1, v2
    v_xor_b32 v5, v5, v3
    v_lshlrev_b32 v6, 7, v2
    v_lshl_add_u32 v6, v5, 4, v6
    s_add_u32 s92, s86, 114688
    v_add_u32 v24, s92, v6
    v_xor_b32 v25, 64, v24
    v_add_u32 v26, 147456, v6
    v_xor_b32 v27, 64, v26
    v_bfe_u32 v5, v1, 2, 2
    v_and_b32 v6, 3, v1
    v_bfe_u32 v7, v1, 3, 2
    v_lshlrev_b32 v7, 5, v7
    v_lshl_add_u32 v7, v6, 3, v7
    v_lshl_add_u32 v7, v5, 7, v7
    v_lshl_add_u32 v28, v3, 10, v7
    v_xor_b32 v30, 32, v28
    v_add_u32 v29, 0x10000, v28
    v_add_u32 v31, 0x10000, v30
    v_lshl_add_u32 v7, v3, 9, v7
    s_add_u32 s92, s86, 0x10000
    v_add_u32 v32, s92, v7
    v_xor_b32 v33, 32, v32
    v_xor_b32 v34, 64, v32
    v_xor_b32 v35, 0x60, v32
    v_lshlrev_b32 v59, 5, v2
    v_add_u32 v59, 159744, v59
    s_mov_b64 s[56:57], s[36:37]
    s_mov_b32 s58, 268435456
    s_mov_b32 s59, 0x20000
    s_lshl3_add_u32 s92, s60, s60
    s_bfe_u32 s92, s92, 0x30001
    s_lshl2_add_u32 s63, s92, s63
    s_mul_i32 s92, s3, 401408
    s_lshl_b32 s93, s68, 7
    s_add_u32 s92, s92, s93
    s_add_u32 s52, s28, s92
    s_addc_u32 s53, s29, 0
    s_mov_b32 s54, 1605632
    s_mov_b32 s55, 0x20000
    s_add_u32 s20, s20, s93
    s_addc_u32 s21, s21, 0
    s_lshl2_add_u32 s97, s63, s3
    s_mul_i32 s97, s97, 14336
    s_add_u32 s97, s97, s93
    s_lshl_b32 s88, s87, 10
    s_lshr_b32 s92, s60, 1
    s_lshl_b32 s92, s92, 7
    s_lshl2_add_u32 s92, s68, s92
    s_add_u32 s88, s88, s92
    s_add_u32 s88, s88, 8192
    s_mul_i32 s87, s87, 344064
    s_lshl_b32 s92, s62, 12
    s_add_u32 s87, s87, s92
    s_add_u32 s87, s87, 2097152
    s_lshl3_add_u32 s89, s63, s3
    s_lshl_b32 s89, s89, 7
    s_add_u32 s89, s89, 8192
    s_lshl3_add_u32 s90, s62, s96
    s_lshl_b32 s90, s90, 8
    s_add_u32 s90, s90, 65536
    s_mul_i32 s92, s63, 12
    s_add_u32 s92, s92, s3
    s_mul_i32 s92, s92, 28672
    s_add_u32 s92, s92, 2097152
    s_add_u32 s64, s36, s92
    s_addc_u32 s65, s37, 0
    s_mov_b32 s66, 28672
    s_mov_b32 s67, 0x20000
    s_add_u32 s93, s61, s68
    s_lshl2_add_u32 s91, s68, s3
    s_mul_i32 s92, s63, 28
    s_add_u32 s92, s92, s91
    s_lshl_b32 s92, s92, 11
    s_add_u32 s92, s92, 13631488
    v_add_u32 v253, s92, v23
    s_mul_i32 s92, s91, 28672
    s_add_u32 s92, s92, 1048576
    s_add_u32 s68, s36, s92
    s_addc_u32 s69, s37, 0
    s_mov_b32 s70, 28672
    s_mov_b32 s71, 0x20000
    s_lshl_b32 s91, s91, 7
    s_add_u32 s91, s91, 4096
    s_mov_b64 s[60:61], s[32:33]
    s_mov_b32 s62, 3670016
    s_mov_b32 s63, 0x20000
    s_bitcmp1_b32 s93, 0
    s_cselect_b32 s92, 15728415, 0
    s_cselect_b32 s95, 4294909696, 0
    s_add_u32 s92, s92, 90452481
    s_add_u32 s95, s95, 106177296
    s_bitcmp1_b32 s93, 1
    s_cselect_b32 s92, s95, s92
    s_bfe_u32 s22, s92, 262144
    s_lshl_b32 s22, s22, 12
    s_mul_i32 s29, s22, 14
    s_bfe_u32 s23, s92, 262148
    s_lshl_b32 s23, s23, 12
    s_mul_i32 s30, s23, 14
    s_bfe_u32 s24, s92, 262152
    s_lshl_b32 s24, s24, 12
    s_mul_i32 s31, s24, 14
    s_bfe_u32 s25, s92, 262156
    s_lshl_b32 s25, s25, 12
    s_mul_i32 s32, s25, 14
    s_bfe_u32 s26, s92, 262160
    s_lshl_b32 s26, s26, 12
    s_mul_i32 s33, s26, 14
    s_bfe_u32 s27, s92, 262164
    s_lshl_b32 s27, s27, 12
    s_mul_i32 s34, s27, 14
    s_bfe_u32 s28, s92, 262168
    s_lshl_b32 s28, s28, 12
    s_mul_i32 s35, s28, 14
    buffer_load_dwordx4 v16, s[48:51], s79 offen offset:2048 lds
    buffer_load_dwordx4 v17, s[48:51], s79 offen offset:3072 lds
    s_add_u32 m0, s1, 147456
    s_nop 0
    buffer_load_dwordx4 v18, s[44:47], s72 offen offset:0 lds
    s_add_u32 m0, s86, 131072
    s_add_u32 s94, s72, 7168
    buffer_load_dwordx4 v10, s[40:43], s94 offen offset:0 lds
    buffer_load_dwordx4 v11, s[40:43], s94 offen offset:1024 lds
    buffer_load_dwordx4 v12, s[40:43], s94 offen offset:2048 lds
    buffer_load_dwordx4 v13, s[40:43], s94 offen offset:3072 lds
    s_waitcnt vmcnt(13)
    ds_read_b128 a[0:3], v24 offset:0
    ds_read_b128 a[4:7], v24 offset:2048
    ds_read_b128 a[16:19], v25 offset:0
    ds_read_b128 a[20:23], v25 offset:2048
    s_waitcnt vmcnt(9)
    v_readfirstlane_b32 s38, v37
    v_and_b32 v4, 1, v1
    s_mul_i32 s38, s38, 2654435761
    s_add_u32 s38, s38, 2135587861
    s_mov_b32 s39, s38
    v_mov_b32 v37, s38
    v_mov_b32 v39, s38
    v_lshlrev_b32 v4, 4, v4
    v_lshrrev_b32 v2, v4, v55
    v_lshrrev_b32 v3, v4, v56
    v_lshrrev_b32 v57, v4, v57
    v_lshlrev_b32 v2, 16, v2
    v_lshlrev_b32 v3, 16, v3
    v_lshlrev_b32 v57, 16, v57
    v_mul_f32 v57, 0x3fb8aa3b, v57
    v_exp_f32 v57, v57
    v_mul_f32 v8, v2, v2
    v_cvt_pk_bf16_f32 v57, v57, v57
    v_lshlrev_b32 v57, 16, v57
    v_mul_f32 v4, v57, v2
    v_mul_f32 v5, v57, v3
    v_mul_f32 v4, 0x3fb8aa3b, v4
    v_mul_f32 v5, 0.15915494, v5
    v_exp_f32 v4, v4
    v_rndne_f32 v6, v5
    v_sub_f32 v5, v5, v6
    v_cos_f32 v6, v5
    v_sin_f32 v7, v5
    v_fmac_f32 v8, v3, v3
    v_rcp_f32 v8, v8
    v_mul_f32 v40, v4, v6
    v_mul_f32 v41, v4, v7
    v_add_f32 v6, -1.0, v40
    v_add_f32 v8, v8, v8
    v_mul_f32 v4, v6, v2
    v_fmac_f32 v4, v41, v3
    v_mul_f32 v5, v41, v2
    v_fma_f32 v5, -v6, v3, v5
    v_mul_f32 v55, v4, v8
    v_mul_f32 v56, v5, v8
    v_sub_f32 v42, 0, v41
    v_mul_f32 v6, v41, v41
    v_mul_f32 v3, v40, v41
    v_fma_f32 v2, v40, v40, -v6
    v_add_f32 v3, v3, v3
    v_mul_f32 v6, v3, v3
    v_mul_f32 v5, v2, v3
    v_fma_f32 v4, v2, v2, -v6
    v_add_f32 v5, v5, v5
    v_mul_f32 v6, v5, v5
    v_mul_f32 v3, v4, v5
    v_fma_f32 v2, v4, v4, -v6
    v_add_f32 v3, v3, v3
    v_mul_f32 v6, v3, v3
    v_mul_f32 v44, v2, v3
    v_fma_f32 v43, v2, v2, -v6
    v_add_f32 v44, v44, v44
    v_mul_f32 v6, v44, v44
    v_mul_f32 v46, v43, v44
    v_fma_f32 v45, v43, v43, -v6
    v_add_f32 v46, v46, v46
    v_mul_f32 v6, v46, v46
    v_mul_f32 v48, v45, v46
    v_fma_f32 v47, v45, v45, -v6
    v_add_f32 v48, v48, v48
    v_mul_f32 v6, v48, v48
    v_mul_f32 v3, v47, v48
    v_fma_f32 v2, v47, v47, -v6
    v_add_f32 v3, v3, v3
    v_mul_f32 v6, v3, v3
    v_mul_f32 v50, v2, v3
    v_fma_f32 v49, v2, v2, -v6
    v_add_f32 v50, v50, v50
    v_mul_f32 v6, v50, v50
    v_mul_f32 v52, v49, v50
    v_fma_f32 v51, v49, v49, -v6
    v_add_f32 v52, v52, v52
    v_mul_f32 v6, v52, v52
    v_mul_f32 v54, v51, v52
    v_fma_f32 v53, v51, v51, -v6
    v_add_f32 v54, v54, v54
    v_mov_b32 v57, v55
    v_mov_b32 v58, v56
    v_lshl_add_u32 v7, s3, 6, v1
    v_bfe_u32 v6, v7, 4, 1
    v_cmp_eq_u32 vcc, 1, v6
    v_mul_f32 v4, v43, v57
    v_mul_f32 v5, v43, v58
    v_fma_f32 v4, -v44, v58, v4
    v_fmac_f32 v5, v44, v57
    v_cndmask_b32 v57, v57, v4, vcc
    v_cndmask_b32 v58, v58, v5, vcc
    v_bfe_u32 v6, v7, 5, 1
    v_cmp_eq_u32 vcc, 1, v6
    v_mul_f32 v4, v45, v57
    v_mul_f32 v5, v45, v58
    v_fma_f32 v4, -v46, v58, v4
    v_fmac_f32 v5, v46, v57
    v_cndmask_b32 v57, v57, v4, vcc
    v_cndmask_b32 v58, v58, v5, vcc
    v_bfe_u32 v6, v7, 6, 1
    v_cmp_eq_u32 vcc, 1, v6
    v_mul_f32 v4, v47, v57
    v_mul_f32 v5, v47, v58
    v_fma_f32 v4, -v48, v58, v4
    v_fmac_f32 v5, v48, v57
    v_cndmask_b32 v57, v57, v4, vcc
    v_cndmask_b32 v58, v58, v5, vcc
    v_bfe_u32 v6, v7, 7, 1
    v_cmp_eq_u32 vcc, 1, v6
    v_mul_f32 v4, v2, v57
    v_mul_f32 v5, v2, v58
    v_fma_f32 v4, -v3, v58, v4
    v_fmac_f32 v5, v3, v57
    v_cndmask_b32 v57, v57, v4, vcc
    v_cndmask_b32 v58, v58, v5, vcc
    s_mov_b32 s0, 1
    s_cmp_eq_u32 s3, 0
    s_cbranch_scc1 L_page1
    s_cmp_eq_u32 s3, 1
    s_cbranch_scc1 L_page2
    s_cmp_eq_u32 s3, 2
    s_cbranch_scc1 L_page3
    s_branch L_page4
L_warm:
    s_mov_b32 s0, 0
    s_branch L_body
.p2align 12
L_body:
    s_add_u32 m0, s86, 16384
    s_nop 0
    buffer_load_dwordx4 v14, s[48:51], s80 offen offset:0 lds
    buffer_load_dwordx4 v15, s[48:51], s80 offen offset:1024 lds
    s_add_u32 m0, s86, 114688
    s_waitcnt lgkmcnt(0)
    buffer_load_dwordx4 v10, s[40:43], s73 offen offset:0 lds
    buffer_load_dwordx4 v11, s[40:43], s73 offen offset:1024 lds
    buffer_load_dwordx4 v12, s[40:43], s73 offen offset:2048 lds
    buffer_load_dwordx4 v13, s[40:43], s73 offen offset:3072 lds
    s_waitcnt vmcnt(6)
    s_barrier
    ds_read_b128 a[224:227], v26 offset:0
    ds_read_b128 a[8:11], v24 offset:16384
    ds_read_b128 a[12:15], v24 offset:18432
    ds_read_b128 a[24:27], v25 offset:16384
    ds_read_b128 a[28:31], v25 offset:18432
    ds_read_b128 a[228:231], v27 offset:0
    ds_read_b64_tr_b16 a[232:233], v28 offset:0
    ds_read_b64_tr_b16 a[234:235], v28 offset:512
    ds_read_b64_tr_b16 a[236:237], v28 offset:4096
    ds_read_b64_tr_b16 a[238:239], v28 offset:4608
    s_add_u32 m0, s86, 16384
    s_waitcnt lgkmcnt(4)
    v_mfma_f32_16x16x32_bf16 v[192:195], a[0:3], a[224:227], 0
    buffer_load_dwordx4 v16, s[48:51], s80 offen offset:2048 lds
    v_mfma_f32_16x16x32_bf16 v[192:195], a[16:19], a[228:231], v[192:195]
    ds_read_b64_tr_b16 a[240:241], v30 offset:0
    ds_read_b64_tr_b16 a[242:243], v30 offset:512
    v_mfma_f32_16x16x32_bf16 v[196:199], a[20:23], a[228:231], 0
    buffer_load_dwordx4 v17, s[48:51], s80 offen offset:3072 lds
    v_mfma_f32_16x16x32_bf16 v[196:199], a[4:7], a[224:227], v[196:199]
    s_add_u32 m0, s1, 151552
    v_and_b32 v2, 15, v1
    v_mfma_f32_16x16x32_bf16 v[200:203], a[8:11], a[224:227], 0
    buffer_load_dwordx4 v18, s[44:47], s73 offen offset:0 lds
    v_mfma_f32_16x16x32_bf16 v[200:203], a[24:27], a[228:231], v[200:203]
    s_add_u32 m0, s86, 131072
    s_add_u32 s94, s73, 7168
    v_mfma_f32_16x16x32_bf16 v[204:207], a[28:31], a[228:231], 0
    ds_read_b64_tr_b16 a[244:245], v30 offset:4096
    ds_read_b64_tr_b16 a[246:247], v30 offset:4608
    v_mfma_f32_16x16x32_bf16 v[204:207], a[12:15], a[224:227], v[204:207]
    v_lshrrev_b32 v3, 4, v1
    s_waitcnt lgkmcnt(4)
    v_mfma_f32_16x16x32_bf16 v[88:91], a[232:235], a[12:15], 0
    buffer_load_dwordx4 v10, s[40:43], s94 offen offset:0 lds
    v_mfma_f32_16x16x32_bf16 v[88:91], a[236:239], a[28:31], v[88:91]
    buffer_load_dwordx4 v11, s[40:43], s94 offen offset:1024 lds
    v_mfma_f32_16x16x32_bf16 v[80:83], a[236:239], a[24:27], 0
    ds_read_b128 a[248:251], v26 offset:2048
    s_sub_u32 s92, s90, 2048
    v_mfma_f32_16x16x32_bf16 v[80:83], a[232:235], a[8:11], v[80:83]
    buffer_load_dwordx4 v12, s[40:43], s94 offen offset:2048 lds
    v_mfma_f32_16x16x32_bf16 v[72:75], a[232:235], a[4:7], 0
    ds_read_b128 a[252:255], v27 offset:2048
    v_lshl_add_u32 v4, v2, 4, s92
    v_mfma_f32_16x16x32_bf16 v[72:75], a[236:239], a[20:23], v[72:75]
    buffer_load_dwordx4 v13, s[40:43], s94 offen offset:3072 lds
    v_mfma_f32_16x16x32_bf16 v[64:67], a[236:239], a[16:19], 0
    s_add_u32 m0, s86, 32768
    v_lshl_add_u32 v234, v3, 9, v4
    v_mfma_f32_16x16x32_bf16 v[64:67], a[232:235], a[0:3], v[64:67]
    v_or_b32 v4, s3, v3
    s_waitcnt lgkmcnt(2)
    v_mfma_f32_16x16x32_bf16 v[68:71], a[240:243], a[0:3], 0
    buffer_load_dwordx4 v14, s[48:51], s81 offen offset:0 lds
    v_mfma_f32_16x16x32_bf16 v[68:71], a[244:247], a[16:19], v[68:71]
    ds_read_b64_tr_b16 a[224:225], v28 offset:8192
    s_waitcnt vmcnt(8)
    v_mfma_f32_16x16x32_bf16 v[76:79], a[244:247], a[20:23], 0
    ds_read_b128 a[32:35], v24 offset:0
    ds_read_b128 a[36:39], v24 offset:2048
    v_mfma_f32_16x16x32_bf16 v[76:79], a[240:243], a[4:7], v[76:79]
    buffer_load_dwordx4 v15, s[48:51], s81 offen offset:1024 lds
    ds_read_b64_tr_b16 a[226:227], v28 offset:8704
    ds_read_b128 a[48:51], v25 offset:0
    v_mfma_f32_16x16x32_bf16 v[84:87], a[240:243], a[8:11], 0
    s_add_u32 m0, s86, 114688
    ds_read_b128 a[52:55], v25 offset:2048
    v_mfma_f32_16x16x32_bf16 v[84:87], a[244:247], a[24:27], v[84:87]
    ds_read_b64_tr_b16 a[228:229], v28 offset:12288
    ds_read_b64_tr_b16 a[230:231], v28 offset:12800
    v_mfma_f32_16x16x32_bf16 v[92:95], a[244:247], a[28:31], 0
    s_waitcnt lgkmcnt(2)
    v_min_u32 v4, 1, v4
    v_mfma_f32_16x16x32_bf16 v[92:95], a[240:243], a[12:15], v[92:95]
    v_add_u32 v5, s90, v23
    v_mfma_f32_16x16x32_bf16 v[220:223], a[12:15], a[248:251], 0
    buffer_load_dwordx4 v10, s[40:43], s74 offen offset:0 lds
    v_mfma_f32_16x16x32_bf16 v[220:223], a[28:31], a[252:255], v[220:223]
    ds_read_b64_tr_b16 a[232:233], v30 offset:8192
    ds_read_b64_tr_b16 a[234:235], v30 offset:8704
    v_mfma_f32_16x16x32_bf16 v[216:219], a[24:27], a[252:255], 0
    v_lshl_or_b32 v235, v4, 31, v5
    v_and_b32 v7, 7, v1
    v_mfma_f32_16x16x32_bf16 v[216:219], a[8:11], a[248:251], v[216:219]
    buffer_load_dwordx4 v11, s[40:43], s74 offen offset:1024 lds
    v_mfma_f32_16x16x32_bf16 v[212:215], a[4:7], a[248:251], 0
    ds_read_b64_tr_b16 a[236:237], v30 offset:12288
    v_lshlrev_b32 v5, 1, v3
    v_mfma_f32_16x16x32_bf16 v[212:215], a[20:23], a[252:255], v[212:215]
    ds_read_b64_tr_b16 a[238:239], v30 offset:12800
    v_xor_b32 v4, v7, v5
    v_mfma_f32_16x16x32_bf16 v[208:211], a[16:19], a[252:255], 0
    buffer_load_dwordx4 v12, s[40:43], s74 offen offset:2048 lds
    v_mfma_f32_16x16x32_bf16 v[208:211], a[0:3], a[248:251], v[208:211]
    v_lshlrev_b32 v5, 7, v2
    s_waitcnt lgkmcnt(4)
    v_mfma_f32_16x16x32_bf16 v[96:99], a[224:227], a[0:3], 0
    s_waitcnt vmcnt(9)
    v_lshl_add_u32 v5, v4, 4, v5
    v_mfma_f32_16x16x32_bf16 v[96:99], a[228:231], a[16:19], v[96:99]
    s_barrier
    ds_read_b128 a[240:243], v26 offset:4096
    v_mfma_f32_16x16x32_bf16 v[104:107], a[228:231], a[20:23], 0
    buffer_load_dwordx4 v13, s[40:43], s74 offen offset:3072 lds
    v_mfma_f32_16x16x32_bf16 v[104:107], a[224:227], a[4:7], v[104:107]
    s_add_u32 m0, s86, 32768
    s_add_u32 s92, s86, 147456
    v_mfma_f32_16x16x32_bf16 v[112:115], a[224:227], a[8:11], 0
    ds_read_b128 a[244:247], v27 offset:4096
    v_add_u32 v236, s92, v5
    v_mfma_f32_16x16x32_bf16 v[112:115], a[228:231], a[24:27], v[112:115]
    v_xor_b32 v237, 16, v236
    v_bfe_u32 v4, v1, 2, 2
    v_mfma_f32_16x16x32_bf16 v[120:123], a[228:231], a[28:31], 0
    buffer_load_dwordx4 v16, s[48:51], s81 offen offset:2048 lds
    v_mfma_f32_16x16x32_bf16 v[120:123], a[224:227], a[12:15], v[120:123]
    s_waitcnt vmcnt(7)
    s_waitcnt lgkmcnt(2)
    v_mfma_f32_16x16x32_bf16 v[124:127], a[232:235], a[12:15], 0
    ds_read_b128 a[40:43], v24 offset:16384
    ds_read_b128 a[44:47], v24 offset:18432
    v_mfma_f32_16x16x32_bf16 v[124:127], a[236:239], a[28:31], v[124:127]
    buffer_load_dwordx4 v17, s[48:51], s81 offen offset:3072 lds
    v_mfma_f32_16x16x32_bf16 v[116:119], a[236:239], a[24:27], 0
    s_add_u32 m0, s1, 155648
    ds_read_b64_tr_b16 a[248:249], v28 offset:16384
    ds_read_b128 a[56:59], v25 offset:16384
    ds_read_b128 a[60:63], v25 offset:18432
    v_mfma_f32_16x16x32_bf16 v[116:119], a[232:235], a[8:11], v[116:119]
    ds_read_b64_tr_b16 a[250:251], v28 offset:16896
    v_and_b32 v5, 3, v1
    v_mfma_f32_16x16x32_bf16 v[108:111], a[232:235], a[4:7], 0
    ds_read_b64_tr_b16 a[252:253], v28 offset:20480
    v_lshlrev_b32 v6, 2, v5
    v_mfma_f32_16x16x32_bf16 v[108:111], a[236:239], a[20:23], v[108:111]
    buffer_load_dwordx4 v18, s[44:47], s74 offen offset:0 lds
    v_mfma_f32_16x16x32_bf16 v[100:103], a[236:239], a[16:19], 0
    s_add_u32 m0, s86, 131072
    s_add_u32 s94, s74, 7168
    v_mfma_f32_16x16x32_bf16 v[100:103], a[232:235], a[0:3], v[100:103]
    ds_read_b64_tr_b16 a[254:255], v28 offset:20992
    s_waitcnt lgkmcnt(3)
    v_mfma_f32_16x16x32_bf16 v[192:195], a[32:35], a[240:243], v[192:195]
    ds_read_b64_tr_b16 a[224:225], v30 offset:16384
    v_add_u32 v245, s91, v6
    v_mfma_f32_16x16x32_bf16 v[192:195], a[48:51], a[244:247], v[192:195]
    buffer_load_dwordx4 v10, s[40:43], s94 offen offset:0 lds
    v_mfma_f32_16x16x32_bf16 v[196:199], a[52:55], a[244:247], v[196:199]
    ds_read_b64_tr_b16 a[226:227], v30 offset:16896
    v_add_u32 v6, 256, v6
    v_mfma_f32_16x16x32_bf16 v[196:199], a[36:39], a[240:243], v[196:199]
    v_lshlrev_b32 v5, 1, v5
    v_xor_b32 v5, v5, v4
    v_mfma_f32_16x16x32_bf16 v[200:203], a[40:43], a[240:243], v[200:203]
    buffer_load_dwordx4 v11, s[40:43], s94 offen offset:1024 lds
    v_mfma_f32_16x16x32_bf16 v[200:203], a[56:59], a[244:247], v[200:203]
    ds_read_b64_tr_b16 a[228:229], v30 offset:20480
    ds_read_b64_tr_b16 a[230:231], v30 offset:20992
    v_mfma_f32_16x16x32_bf16 v[204:207], a[60:63], a[244:247], v[204:207]
    v_lshl_add_u32 v4, v3, 3, v4
    v_lshlrev_b32 v4, 7, v4
    v_mfma_f32_16x16x32_bf16 v[204:207], a[44:47], a[240:243], v[204:207]
    v_lshl_add_u32 v4, v5, 4, v4
    s_waitcnt lgkmcnt(4)
    v_mfma_f32_16x16x32_bf16 v[88:91], a[248:251], a[44:47], v[88:91]
    buffer_load_dwordx4 v12, s[40:43], s94 offen offset:2048 lds
    v_mfma_f32_16x16x32_bf16 v[88:91], a[252:255], a[60:63], v[88:91]
    ds_read_b128 a[232:235], v26 offset:6144
    v_add_u32 v238, s92, v4
    v_mfma_f32_16x16x32_bf16 v[80:83], a[252:255], a[56:59], v[80:83]
    buffer_load_dwordx4 v13, s[40:43], s94 offen offset:3072 lds
    v_mfma_f32_16x16x32_bf16 v[80:83], a[248:251], a[40:43], v[80:83]
    s_add_u32 m0, s86, 49152
    v_xor_b32 v239, 16, v238
    v_mfma_f32_16x16x32_bf16 v[72:75], a[248:251], a[36:39], v[72:75]
    ds_read_b128 a[236:239], v27 offset:6144
    v_xor_b32 v240, 64, v238
    v_mfma_f32_16x16x32_bf16 v[72:75], a[252:255], a[52:55], v[72:75]
    buffer_load_dwordx4 v14, s[48:51], s82 offen offset:0 lds
    v_mfma_f32_16x16x32_bf16 v[64:67], a[252:255], a[48:51], v[64:67]
    s_waitcnt vmcnt(8)
    ds_read_b128 a[64:67], v24 offset:0
    v_mfma_f32_16x16x32_bf16 v[64:67], a[248:251], a[32:35], v[64:67]
    ds_read_b128 a[68:71], v24 offset:2048
    s_waitcnt lgkmcnt(4)
    v_mfma_f32_16x16x32_bf16 v[68:71], a[224:227], a[32:35], v[68:71]
    buffer_load_dwordx4 v15, s[48:51], s82 offen offset:1024 lds
    v_mfma_f32_16x16x32_bf16 v[68:71], a[228:231], a[48:51], v[68:71]
    s_add_u32 m0, s86, 114688
    ds_read_b128 a[80:83], v25 offset:0
    v_mfma_f32_16x16x32_bf16 v[76:79], a[228:231], a[52:55], v[76:79]
    ds_read_b128 a[84:87], v25 offset:2048
    ds_read_b64_tr_b16 a[240:241], v28 offset:24576
    v_mfma_f32_16x16x32_bf16 v[76:79], a[224:227], a[36:39], v[76:79]
    s_waitcnt lgkmcnt(1)
    ds_read_b64_tr_b16 a[242:243], v28 offset:25088
    v_mfma_f32_16x16x32_bf16 v[84:87], a[224:227], a[40:43], v[84:87]
    buffer_load_dwordx4 v10, s[40:43], s75 offen offset:0 lds
    v_mfma_f32_16x16x32_bf16 v[84:87], a[228:231], a[56:59], v[84:87]
    ds_read_b64_tr_b16 a[244:245], v28 offset:28672
    ds_read_b64_tr_b16 a[246:247], v28 offset:29184
    v_mfma_f32_16x16x32_bf16 v[92:95], a[228:231], a[60:63], v[92:95]
    buffer_load_dwordx4 v11, s[40:43], s75 offen offset:1024 lds
    v_mfma_f32_16x16x32_bf16 v[92:95], a[224:227], a[44:47], v[92:95]
    v_xor_b32 v241, 0x50, v238
    v_mfma_f32_16x16x32_bf16 v[220:223], a[44:47], a[232:235], v[220:223]
    s_waitcnt vmcnt(8)
    v_lshl_add_u32 v246, s3, 3, v59
    v_mfma_f32_16x16x32_bf16 v[220:223], a[60:63], a[236:239], v[220:223]
    buffer_load_dwordx4 v12, s[40:43], s75 offen offset:2048 lds
    v_mfma_f32_16x16x32_bf16 v[216:219], a[56:59], a[236:239], v[216:219]
    s_barrier
    ds_read_b128 a[248:251], v26 offset:8192
    v_mfma_f32_16x16x32_bf16 v[216:219], a[40:43], a[232:235], v[216:219]
    s_add_u32 s92, s92, 2048
    v_lshl_add_u32 v247, v1, 2, s92
    v_mfma_f32_16x16x32_bf16 v[212:215], a[36:39], a[232:235], v[212:215]
    buffer_load_dwordx4 v13, s[40:43], s75 offen offset:3072 lds
    v_mfma_f32_16x16x32_bf16 v[212:215], a[52:55], a[236:239], v[212:215]
    s_add_u32 m0, s86, 49152
    ds_read_b128 a[252:255], v27 offset:8192
    v_mfma_f32_16x16x32_bf16 v[208:211], a[48:51], a[236:239], v[208:211]
    v_lshl_add_u32 v248, v3, 4, s92
    s_sub_u32 s92, s88, 8192
    v_mfma_f32_16x16x32_bf16 v[208:211], a[32:35], a[232:235], v[208:211]
    s_lshr_b32 s92, s92, 10
    s_waitcnt lgkmcnt(2)
    v_mfma_f32_16x16x32_bf16 v[96:99], a[240:243], a[32:35], v[96:99]
    buffer_load_dwordx4 v16, s[48:51], s82 offen offset:2048 lds
    v_mfma_f32_16x16x32_bf16 v[96:99], a[244:247], a[48:51], v[96:99]
    ds_read_b64_tr_b16 a[224:225], v28 offset:32768
    s_waitcnt vmcnt(7)
    v_mfma_f32_16x16x32_bf16 v[104:107], a[244:247], a[52:55], v[104:107]
    ds_read_b128 a[72:75], v24 offset:16384
    ds_read_b128 a[76:79], v24 offset:18432
    v_mfma_f32_16x16x32_bf16 v[104:107], a[240:243], a[36:39], v[104:107]
    buffer_load_dwordx4 v17, s[48:51], s82 offen offset:3072 lds
    ds_read_b64_tr_b16 a[226:227], v28 offset:33280
    ds_read_b128 a[88:91], v25 offset:16384
    v_mfma_f32_16x16x32_bf16 v[112:115], a[240:243], a[40:43], v[112:115]
    s_add_u32 m0, s1, 147456
    ds_read_b128 a[92:95], v25 offset:18432
    v_mfma_f32_16x16x32_bf16 v[112:115], a[244:247], a[56:59], v[112:115]
    ds_read_b64_tr_b16 a[228:229], v28 offset:36864
    ds_read_b64_tr_b16 a[230:231], v28 offset:37376
    v_mfma_f32_16x16x32_bf16 v[120:123], a[244:247], a[60:63], v[120:123]
    buffer_load_dwordx4 v18, s[44:47], s75 offen offset:0 lds
    v_mfma_f32_16x16x32_bf16 v[120:123], a[240:243], a[44:47], v[120:123]
    s_add_u32 m0, s86, 131072
    s_waitcnt lgkmcnt(2)
    v_mfma_f32_16x16x32_bf16 v[204:207], a[76:79], a[248:251], v[204:207]
    s_add_u32 s94, s75, 7168
    ds_read_b64_tr_b16 a[232:233], v30 offset:32768
    v_mfma_f32_16x16x32_bf16 v[204:207], a[92:95], a[252:255], v[204:207]
    buffer_load_dwordx4 v10, s[40:43], s94 offen offset:0 lds
    v_mfma_f32_16x16x32_bf16 v[200:203], a[88:91], a[252:255], v[200:203]
    ds_read_b64_tr_b16 a[234:235], v30 offset:33280
    s_lshl_b32 s92, s92, 9
    v_mfma_f32_16x16x32_bf16 v[200:203], a[72:75], a[248:251], v[200:203]
    s_add_u32 s92, s92, 49152
    v_lshl_add_u32 v244, v1, 2, s92
    v_mfma_f32_16x16x32_bf16 v[196:199], a[68:71], a[248:251], v[196:199]
    buffer_load_dwordx4 v11, s[40:43], s94 offen offset:1024 lds
    v_mfma_f32_16x16x32_bf16 v[196:199], a[84:87], a[252:255], v[196:199]
    ds_read_b64_tr_b16 a[236:237], v30 offset:36864
    ds_read_b64_tr_b16 a[238:239], v30 offset:37376
    v_mfma_f32_16x16x32_bf16 v[192:195], a[80:83], a[252:255], v[192:195]
    v_add_u32 v4, s92, v6
    v_cmp_eq_u32 vcc, 2, v3
    v_mfma_f32_16x16x32_bf16 v[192:195], a[64:67], a[248:251], v[192:195]
    s_nop 0
    v_cndmask_b32 v245, v245, v4, vcc
    s_waitcnt lgkmcnt(4)
    v_mfma_f32_16x16x32_bf16 v[64:67], a[224:227], a[64:67], v[64:67]
    buffer_load_dwordx4 v12, s[40:43], s94 offen offset:2048 lds
    v_mfma_f32_16x16x32_bf16 v[64:67], a[228:231], a[80:83], v[64:67]
    ds_read_b128 a[240:243], v26 offset:10240
    v_xor_b32 v4, v7, v3
    v_mfma_f32_16x16x32_bf16 v[72:75], a[228:231], a[84:87], v[72:75]
    buffer_load_dwordx4 v13, s[40:43], s94 offen offset:3072 lds
    v_mfma_f32_16x16x32_bf16 v[72:75], a[224:227], a[68:71], v[72:75]
    s_add_u32 m0, s86, 65536
    v_lshlrev_b32 v4, 4, v4
    v_mfma_f32_16x16x32_bf16 v[80:83], a[224:227], a[72:75], v[80:83]
    ds_read_b128 a[244:247], v27 offset:10240
    v_lshl_add_u32 v4, v2, 8, v4
    v_mfma_f32_16x16x32_bf16 v[80:83], a[228:231], a[88:91], v[80:83]
    buffer_load_dwordx4 v14, s[48:51], s83 offen offset:0 lds
    v_mfma_f32_16x16x32_bf16 v[88:91], a[228:231], a[92:95], v[88:91]
    s_waitcnt vmcnt(8)
    ds_read_b128 a[96:99], v24 offset:0
    v_mfma_f32_16x16x32_bf16 v[88:91], a[224:227], a[76:79], v[88:91]
    ds_read_b128 a[100:103], v24 offset:2048
    s_waitcnt lgkmcnt(4)
    v_mfma_f32_16x16x32_bf16 v[92:95], a[232:235], a[76:79], v[92:95]
    buffer_load_dwordx4 v15, s[48:51], s83 offen offset:1024 lds
    v_mfma_f32_16x16x32_bf16 v[92:95], a[236:239], a[92:95], v[92:95]
    s_add_u32 m0, s86, 114688
    ds_read_b128 a[112:115], v25 offset:0
    v_mfma_f32_16x16x32_bf16 v[84:87], a[236:239], a[88:91], v[84:87]
    ds_read_b128 a[116:119], v25 offset:2048
    ds_read_b64_tr_b16 a[248:249], v28 offset:40960
    v_mfma_f32_16x16x32_bf16 v[84:87], a[232:235], a[72:75], v[84:87]
    s_waitcnt lgkmcnt(1)
    ds_read_b64_tr_b16 a[250:251], v28 offset:41472
    v_mfma_f32_16x16x32_bf16 v[76:79], a[232:235], a[68:71], v[76:79]
    buffer_load_dwordx4 v10, s[40:43], s76 offen offset:0 lds
    v_mfma_f32_16x16x32_bf16 v[76:79], a[236:239], a[84:87], v[76:79]
    ds_read_b64_tr_b16 a[252:253], v28 offset:45056
    ds_read_b64_tr_b16 a[254:255], v28 offset:45568
    v_mfma_f32_16x16x32_bf16 v[68:71], a[236:239], a[80:83], v[68:71]
    buffer_load_dwordx4 v11, s[40:43], s76 offen offset:1024 lds
    v_mfma_f32_16x16x32_bf16 v[68:71], a[232:235], a[64:67], v[68:71]
    v_add_u32 v249, s86, v4
    v_mfma_f32_16x16x32_bf16 v[208:211], a[64:67], a[240:243], v[208:211]
    s_waitcnt vmcnt(8)
    v_xor_b32 v250, 64, v249
    v_mfma_f32_16x16x32_bf16 v[208:211], a[80:83], a[244:247], v[208:211]
    buffer_load_dwordx4 v12, s[40:43], s76 offen offset:2048 lds
    v_mfma_f32_16x16x32_bf16 v[212:215], a[84:87], a[244:247], v[212:215]
    s_barrier
    ds_read_b128 a[224:227], v26 offset:0
    v_mfma_f32_16x16x32_bf16 v[212:215], a[68:71], a[240:243], v[212:215]
    v_lshl_add_u32 v4, s3, 2, v3
    v_and_b32 v5, 7, v4
    v_mfma_f32_16x16x32_bf16 v[216:219], a[72:75], a[240:243], v[216:219]
    buffer_load_dwordx4 v13, s[40:43], s76 offen offset:3072 lds
    v_mfma_f32_16x16x32_bf16 v[216:219], a[88:91], a[244:247], v[216:219]
    s_add_u32 m0, s86, 65536
    ds_read_b128 a[228:231], v27 offset:0
    v_mfma_f32_16x16x32_bf16 v[220:223], a[92:95], a[244:247], v[220:223]
    v_xor_b32 v5, v2, v5
    v_lshlrev_b32 v5, 4, v5
    v_mfma_f32_16x16x32_bf16 v[220:223], a[76:79], a[240:243], v[220:223]
    v_lshl_add_u32 v251, v4, 8, v5
    s_waitcnt lgkmcnt(2)
    v_mfma_f32_16x16x32_bf16 v[120:123], a[248:251], a[76:79], v[120:123]
    buffer_load_dwordx4 v16, s[48:51], s83 offen offset:2048 lds
    v_mfma_f32_16x16x32_bf16 v[120:123], a[252:255], a[92:95], v[120:123]
    ds_read_b64_tr_b16 a[232:233], v28 offset:49152
    s_waitcnt vmcnt(7)
    v_mfma_f32_16x16x32_bf16 v[112:115], a[252:255], a[88:91], v[112:115]
    ds_read_b128 a[104:107], v24 offset:16384
    ds_read_b128 a[108:111], v24 offset:18432
    v_mfma_f32_16x16x32_bf16 v[112:115], a[248:251], a[72:75], v[112:115]
    buffer_load_dwordx4 v17, s[48:51], s83 offen offset:3072 lds
    ds_read_b64_tr_b16 a[234:235], v28 offset:49664
    ds_read_b128 a[120:123], v25 offset:16384
    v_mfma_f32_16x16x32_bf16 v[104:107], a[248:251], a[68:71], v[104:107]
    s_add_u32 m0, s1, 151552
    ds_read_b128 a[124:127], v25 offset:18432
    v_mfma_f32_16x16x32_bf16 v[104:107], a[252:255], a[84:87], v[104:107]
    ds_read_b64_tr_b16 a[236:237], v28 offset:53248
    ds_read_b64_tr_b16 a[238:239], v28 offset:53760
    v_mfma_f32_16x16x32_bf16 v[96:99], a[252:255], a[80:83], v[96:99]
    buffer_load_dwordx4 v18, s[44:47], s76 offen offset:0 lds
    v_mfma_f32_16x16x32_bf16 v[96:99], a[248:251], a[64:67], v[96:99]
    s_add_u32 m0, s86, 131072
    s_waitcnt lgkmcnt(2)
    v_mfma_f32_16x16x32_bf16 v[192:195], a[96:99], a[224:227], v[192:195]
    s_add_u32 s94, s76, 7168
    ds_read_b64_tr_b16 a[240:241], v30 offset:49152
    v_mfma_f32_16x16x32_bf16 v[192:195], a[112:115], a[228:231], v[192:195]
    buffer_load_dwordx4 v10, s[40:43], s94 offen offset:0 lds
    v_mfma_f32_16x16x32_bf16 v[196:199], a[116:119], a[228:231], v[196:199]
    ds_read_b64_tr_b16 a[242:243], v30 offset:49664
    v_mul_u32_u24 v4, 896, v3
    v_mfma_f32_16x16x32_bf16 v[196:199], a[100:103], a[224:227], v[196:199]
    v_lshlrev_b32 v233, 3, v2
    v_add3_u32 v4, v4, v233, s97
    v_mfma_f32_16x16x32_bf16 v[200:203], a[104:107], a[224:227], v[200:203]
    ds_read_b64_tr_b16 a[244:245], v30 offset:53248
    v_lshlrev_b32 v242, 1, v4
    v_mfma_f32_16x16x32_bf16 v[200:203], a[120:123], a[228:231], v[200:203]
    buffer_load_dwordx4 v11, s[40:43], s94 offen offset:1024 lds
    v_mfma_f32_16x16x32_bf16 v[204:207], a[124:127], a[228:231], v[204:207]
    ds_read_b64_tr_b16 a[246:247], v30 offset:53760
    s_add_u32 s90, s87, 114688
    v_mfma_f32_16x16x32_bf16 v[204:207], a[108:111], a[224:227], v[204:207]
    s_add_u32 s91, s87, 229376
    s_waitcnt lgkmcnt(4)
    v_mfma_f32_16x16x32_bf16 v[88:91], a[232:235], a[108:111], v[88:91]
    ds_read_b128 a[248:251], v26 offset:2048
    v_mfma_f32_16x16x32_bf16 v[88:91], a[236:239], a[124:127], v[88:91]
    buffer_load_dwordx4 v12, s[40:43], s94 offen offset:2048 lds
    v_mfma_f32_16x16x32_bf16 v[80:83], a[236:239], a[120:123], v[80:83]
    v_mfma_f32_16x16x32_bf16 v[80:83], a[232:235], a[104:107], v[80:83]
    v_mfma_f32_16x16x32_bf16 v[72:75], a[232:235], a[100:103], v[72:75]
    ds_read_b128 a[252:255], v27 offset:2048
    v_mfma_f32_16x16x32_bf16 v[72:75], a[236:239], a[116:119], v[72:75]
    v_mfma_f32_16x16x32_bf16 v[64:67], a[236:239], a[112:115], v[64:67]
    buffer_load_dwordx4 v13, s[40:43], s94 offen offset:3072 lds
    v_mfma_f32_16x16x32_bf16 v[64:67], a[232:235], a[96:99], v[64:67]
    s_add_u32 m0, s86, 81920
    s_waitcnt lgkmcnt(2)
    v_mfma_f32_16x16x32_bf16 v[68:71], a[240:243], a[96:99], v[68:71]
    ds_read_b64_tr_b16 a[224:225], v28 offset:57344
    v_mfma_f32_16x16x32_bf16 v[68:71], a[244:247], a[112:115], v[68:71]
    ds_read_b64_tr_b16 a[226:227], v28 offset:57856
    v_mfma_f32_16x16x32_bf16 v[76:79], a[244:247], a[116:119], v[76:79]
    buffer_load_dwordx4 v14, s[48:51], s84 offen offset:0 lds
    v_mfma_f32_16x16x32_bf16 v[76:79], a[240:243], a[100:103], v[76:79]
    s_waitcnt vmcnt(8)
    ds_read_b128 a[128:131], v24 offset:0
    v_mfma_f32_16x16x32_bf16 v[84:87], a[240:243], a[104:107], v[84:87]
    ds_read_b128 a[132:135], v24 offset:2048
    ds_read_b64_tr_b16 a[228:229], v28 offset:61440
    v_mfma_f32_16x16x32_bf16 v[84:87], a[244:247], a[120:123], v[84:87]
    ds_read_b128 a[144:147], v25 offset:0
    ds_read_b128 a[148:151], v25 offset:2048
    v_mfma_f32_16x16x32_bf16 v[92:95], a[244:247], a[124:127], v[92:95]
    buffer_load_dwordx4 v15, s[48:51], s84 offen offset:1024 lds
    v_mfma_f32_16x16x32_bf16 v[92:95], a[240:243], a[108:111], v[92:95]
    ds_read_b64_tr_b16 a[230:231], v28 offset:61952
    s_waitcnt lgkmcnt(8)
    v_mfma_f32_16x16x32_bf16 v[220:223], a[108:111], a[248:251], v[220:223]
    s_add_u32 m0, s86, 114688
    ds_read_b64_tr_b16 a[232:233], v30 offset:57344
    v_mfma_f32_16x16x32_bf16 v[220:223], a[124:127], a[252:255], v[220:223]
    ds_read_b64_tr_b16 a[234:235], v30 offset:57856
    v_mfma_f32_16x16x32_bf16 v[216:219], a[120:123], a[252:255], v[216:219]
    s_waitcnt lgkmcnt(3)
    v_mfma_f32_16x16x32_bf16 v[216:219], a[104:107], a[248:251], v[216:219]
    buffer_load_dwordx4 v10, s[40:43], s77 offen offset:0 lds
    v_mfma_f32_16x16x32_bf16 v[212:215], a[100:103], a[248:251], v[212:215]
    ds_read_b64_tr_b16 a[236:237], v30 offset:61440
    v_mfma_f32_16x16x32_bf16 v[212:215], a[116:119], a[252:255], v[212:215]
    ds_read_b64_tr_b16 a[238:239], v30 offset:61952
    v_mfma_f32_16x16x32_bf16 v[208:211], a[112:115], a[252:255], v[208:211]
    v_mfma_f32_16x16x32_bf16 v[208:211], a[96:99], a[248:251], v[208:211]
    s_waitcnt lgkmcnt(4)
    v_mfma_f32_16x16x32_bf16 v[96:99], a[224:227], a[96:99], v[96:99]
    buffer_load_dwordx4 v11, s[40:43], s77 offen offset:1024 lds
    v_mfma_f32_16x16x32_bf16 v[96:99], a[228:231], a[112:115], v[96:99]
    ds_read_b64_tr_b16 a[240:241], v30 offset:24576
    ds_read_b64_tr_b16 a[242:243], v30 offset:25088
    v_mfma_f32_16x16x32_bf16 v[104:107], a[228:231], a[116:119], v[104:107]
    v_mfma_f32_16x16x32_bf16 v[104:107], a[224:227], a[100:103], v[104:107]
    buffer_load_dwordx4 v12, s[40:43], s77 offen offset:2048 lds
    v_mfma_f32_16x16x32_bf16 v[112:115], a[224:227], a[104:107], v[112:115]
    ds_read_b64_tr_b16 a[244:245], v30 offset:28672
    v_mfma_f32_16x16x32_bf16 v[112:115], a[228:231], a[120:123], v[112:115]
    ds_read_b64_tr_b16 a[246:247], v30 offset:29184
    v_mfma_f32_16x16x32_bf16 v[120:123], a[228:231], a[124:127], v[120:123]
    v_mfma_f32_16x16x32_bf16 v[120:123], a[224:227], a[108:111], v[120:123]
    s_waitcnt lgkmcnt(4)
    v_mfma_f32_16x16x32_bf16 v[124:127], a[232:235], a[108:111], v[124:127]
    buffer_load_dwordx4 v13, s[40:43], s77 offen offset:3072 lds
    v_mfma_f32_16x16x32_bf16 v[124:127], a[236:239], a[124:127], v[124:127]
    s_add_u32 m0, s86, 81920
    s_waitcnt vmcnt(10)
    v_mfma_f32_16x16x32_bf16 v[116:119], a[236:239], a[120:123], v[116:119]
    s_barrier
    ds_read_b128 a[248:251], v26 offset:4096
    v_mfma_f32_16x16x32_bf16 v[116:119], a[232:235], a[104:107], v[116:119]
    v_mfma_f32_16x16x32_bf16 v[108:111], a[232:235], a[100:103], v[108:111]
    buffer_load_dwordx4 v16, s[48:51], s84 offen offset:2048 lds
    v_mfma_f32_16x16x32_bf16 v[108:111], a[236:239], a[116:119], v[108:111]
    ds_read_b128 a[252:255], v27 offset:4096
    s_waitcnt vmcnt(7)
    v_mfma_f32_16x16x32_bf16 v[100:103], a[236:239], a[112:115], v[100:103]
    ds_read_b128 a[136:139], v24 offset:16384
    ds_read_b128 a[140:143], v24 offset:18432
    v_mfma_f32_16x16x32_bf16 v[100:103], a[232:235], a[96:99], v[100:103]
    ds_read_b128 a[152:155], v25 offset:16384
    s_waitcnt lgkmcnt(5)
    v_mfma_f32_16x16x32_bf16 v[100:103], a[240:243], a[32:35], v[100:103]
    buffer_load_dwordx4 v17, s[48:51], s84 offen offset:3072 lds
    ds_read_b128 a[156:159], v25 offset:18432
    v_mfma_f32_16x16x32_bf16 v[100:103], a[244:247], a[48:51], v[100:103]
    s_add_u32 m0, s1, 155648
    ds_read_b64_tr_b16 a[224:225], v29 offset:0
    v_mfma_f32_16x16x32_bf16 v[108:111], a[244:247], a[52:55], v[108:111]
    ds_read_b64_tr_b16 a[226:227], v29 offset:512
    v_mfma_f32_16x16x32_bf16 v[108:111], a[240:243], a[36:39], v[108:111]
    v_mfma_f32_16x16x32_bf16 v[116:119], a[240:243], a[40:43], v[116:119]
    buffer_load_dwordx4 v18, s[44:47], s77 offen offset:0 lds
    v_mfma_f32_16x16x32_bf16 v[116:119], a[244:247], a[56:59], v[116:119]
    ds_read_b64_tr_b16 a[228:229], v29 offset:4096
    ds_read_b64_tr_b16 a[230:231], v29 offset:4608
    v_mfma_f32_16x16x32_bf16 v[124:127], a[244:247], a[60:63], v[124:127]
    s_add_u32 m0, s86, 131072
    s_add_u32 s94, s77, 7168
    v_mfma_f32_16x16x32_bf16 v[124:127], a[240:243], a[44:47], v[124:127]
    s_waitcnt lgkmcnt(4)
    v_mfma_f32_16x16x32_bf16 v[204:207], a[140:143], a[248:251], v[204:207]
    ds_read_b64_tr_b16 a[232:233], v31 offset:0
    v_mfma_f32_16x16x32_bf16 v[204:207], a[156:159], a[252:255], v[204:207]
    buffer_load_dwordx4 v10, s[40:43], s94 offen offset:0 lds
    v_mfma_f32_16x16x32_bf16 v[200:203], a[152:155], a[252:255], v[200:203]
    ds_read_b64_tr_b16 a[234:235], v31 offset:512
    v_mfma_f32_16x16x32_bf16 v[200:203], a[136:139], a[248:251], v[200:203]
    v_mfma_f32_16x16x32_bf16 v[196:199], a[132:135], a[248:251], v[196:199]
    ds_read_b64_tr_b16 a[236:237], v31 offset:4096
    v_mfma_f32_16x16x32_bf16 v[196:199], a[148:151], a[252:255], v[196:199]
    buffer_load_dwordx4 v11, s[40:43], s94 offen offset:1024 lds
    v_mfma_f32_16x16x32_bf16 v[192:195], a[144:147], a[252:255], v[192:195]
    ds_read_b64_tr_b16 a[238:239], v31 offset:4608
    v_mfma_f32_16x16x32_bf16 v[192:195], a[128:131], a[248:251], v[192:195]
    s_waitcnt lgkmcnt(4)
    v_mfma_f32_16x16x32_bf16 v[64:67], a[224:227], a[128:131], v[64:67]
    ds_read_b128 a[240:243], v26 offset:6144
    v_mfma_f32_16x16x32_bf16 v[64:67], a[228:231], a[144:147], v[64:67]
    buffer_load_dwordx4 v12, s[40:43], s94 offen offset:2048 lds
    v_mfma_f32_16x16x32_bf16 v[72:75], a[228:231], a[148:151], v[72:75]
    v_mfma_f32_16x16x32_bf16 v[72:75], a[224:227], a[132:135], v[72:75]
    v_mfma_f32_16x16x32_bf16 v[80:83], a[224:227], a[136:139], v[80:83]
    ds_read_b128 a[244:247], v27 offset:6144
    v_mfma_f32_16x16x32_bf16 v[80:83], a[228:231], a[152:155], v[80:83]
    v_mfma_f32_16x16x32_bf16 v[88:91], a[228:231], a[156:159], v[88:91]
    buffer_load_dwordx4 v13, s[40:43], s94 offen offset:3072 lds
    v_mfma_f32_16x16x32_bf16 v[88:91], a[224:227], a[140:143], v[88:91]
    s_add_u32 m0, s86, 98304
    s_waitcnt lgkmcnt(2)
    v_mfma_f32_16x16x32_bf16 v[92:95], a[232:235], a[140:143], v[92:95]
    ds_read_b64_tr_b16 a[248:249], v29 offset:8192
    v_mfma_f32_16x16x32_bf16 v[92:95], a[236:239], a[156:159], v[92:95]
    ds_read_b64_tr_b16 a[250:251], v29 offset:8704
    v_mfma_f32_16x16x32_bf16 v[84:87], a[236:239], a[152:155], v[84:87]
    buffer_load_dwordx4 v14, s[48:51], s85 offen offset:0 lds
    v_mfma_f32_16x16x32_bf16 v[84:87], a[232:235], a[136:139], v[84:87]
    s_waitcnt vmcnt(8)
    ds_read_b128 a[160:163], v24 offset:0
    v_mfma_f32_16x16x32_bf16 v[76:79], a[232:235], a[132:135], v[76:79]
    ds_read_b128 a[164:167], v24 offset:2048
    ds_read_b64_tr_b16 a[252:253], v29 offset:12288
    v_mfma_f32_16x16x32_bf16 v[76:79], a[236:239], a[148:151], v[76:79]
    ds_read_b128 a[176:179], v25 offset:0
    ds_read_b128 a[180:183], v25 offset:2048
    v_mfma_f32_16x16x32_bf16 v[68:71], a[236:239], a[144:147], v[68:71]
    buffer_load_dwordx4 v15, s[48:51], s85 offen offset:1024 lds
    v_mfma_f32_16x16x32_bf16 v[68:71], a[232:235], a[128:131], v[68:71]
    ds_read_b64_tr_b16 a[254:255], v29 offset:12800
    s_waitcnt lgkmcnt(8)
    v_mfma_f32_16x16x32_bf16 v[208:211], a[128:131], a[240:243], v[208:211]
    s_add_u32 m0, s86, 114688
    ds_read_b64_tr_b16 a[224:225], v31 offset:8192
    v_mfma_f32_16x16x32_bf16 v[208:211], a[144:147], a[244:247], v[208:211]
    ds_read_b64_tr_b16 a[226:227], v31 offset:8704
    v_mfma_f32_16x16x32_bf16 v[212:215], a[148:151], a[244:247], v[212:215]
    s_waitcnt lgkmcnt(3)
    v_mfma_f32_16x16x32_bf16 v[212:215], a[132:135], a[240:243], v[212:215]
    buffer_load_dwordx4 v10, s[40:43], s78 offen offset:0 lds
    v_mfma_f32_16x16x32_bf16 v[216:219], a[136:139], a[240:243], v[216:219]
    ds_read_b64_tr_b16 a[228:229], v31 offset:12288
    v_mfma_f32_16x16x32_bf16 v[216:219], a[152:155], a[244:247], v[216:219]
L_page1:
    s_cmp_eq_u32 s0, 1
    s_cbranch_scc1 L_warm
    ds_read_b64_tr_b16 a[230:231], v31 offset:12800
    v_mfma_f32_16x16x32_bf16 v[220:223], a[156:159], a[244:247], v[220:223]
    v_mfma_f32_16x16x32_bf16 v[220:223], a[140:143], a[240:243], v[220:223]
    s_waitcnt lgkmcnt(4)
    v_mfma_f32_16x16x32_bf16 v[120:123], a[248:251], a[140:143], v[120:123]
    buffer_load_dwordx4 v11, s[40:43], s78 offen offset:1024 lds
    v_mfma_f32_16x16x32_bf16 v[120:123], a[252:255], a[156:159], v[120:123]
    ds_read_b64_tr_b16 a[232:233], v30 offset:40960
    ds_read_b64_tr_b16 a[234:235], v30 offset:41472
    v_mfma_f32_16x16x32_bf16 v[112:115], a[252:255], a[152:155], v[112:115]
    v_mfma_f32_16x16x32_bf16 v[112:115], a[248:251], a[136:139], v[112:115]
    buffer_load_dwordx4 v12, s[40:43], s78 offen offset:2048 lds
    v_mfma_f32_16x16x32_bf16 v[104:107], a[248:251], a[132:135], v[104:107]
    ds_read_b64_tr_b16 a[236:237], v30 offset:45056
    v_mfma_f32_16x16x32_bf16 v[104:107], a[252:255], a[148:151], v[104:107]
    ds_read_b64_tr_b16 a[238:239], v30 offset:45568
    v_mfma_f32_16x16x32_bf16 v[96:99], a[252:255], a[144:147], v[96:99]
    v_mfma_f32_16x16x32_bf16 v[96:99], a[248:251], a[128:131], v[96:99]
    s_waitcnt lgkmcnt(4)
    v_mfma_f32_16x16x32_bf16 v[100:103], a[224:227], a[128:131], v[100:103]
    buffer_load_dwordx4 v13, s[40:43], s78 offen offset:3072 lds
    v_mfma_f32_16x16x32_bf16 v[100:103], a[228:231], a[144:147], v[100:103]
    s_add_u32 m0, s86, 98304
    s_waitcnt vmcnt(10)
    v_mfma_f32_16x16x32_bf16 v[108:111], a[228:231], a[148:151], v[108:111]
    s_barrier
    ds_read_b128 a[240:243], v26 offset:8192
    v_mfma_f32_16x16x32_bf16 v[108:111], a[224:227], a[132:135], v[108:111]
    v_mfma_f32_16x16x32_bf16 v[116:119], a[224:227], a[136:139], v[116:119]
    buffer_load_dwordx4 v16, s[48:51], s85 offen offset:2048 lds
    v_mfma_f32_16x16x32_bf16 v[116:119], a[228:231], a[152:155], v[116:119]
    ds_read_b128 a[244:247], v27 offset:8192
    s_waitcnt vmcnt(7)
    v_mfma_f32_16x16x32_bf16 v[124:127], a[228:231], a[156:159], v[124:127]
    ds_read_b128 a[168:171], v24 offset:16384
    ds_read_b128 a[172:175], v24 offset:18432
    v_mfma_f32_16x16x32_bf16 v[124:127], a[224:227], a[140:143], v[124:127]
    ds_read_b128 a[184:187], v25 offset:16384
    s_waitcnt lgkmcnt(5)
    v_mfma_f32_16x16x32_bf16 v[124:127], a[232:235], a[76:79], v[124:127]
    buffer_load_dwordx4 v17, s[48:51], s85 offen offset:3072 lds
    ds_read_b128 a[188:191], v25 offset:18432
    v_mfma_f32_16x16x32_bf16 v[124:127], a[236:239], a[92:95], v[124:127]
    s_add_u32 m0, s1, 147456
    ds_read_b64_tr_b16 a[248:249], v29 offset:16384
    v_mfma_f32_16x16x32_bf16 v[116:119], a[236:239], a[88:91], v[116:119]
    ds_read_b64_tr_b16 a[250:251], v29 offset:16896
    v_mfma_f32_16x16x32_bf16 v[116:119], a[232:235], a[72:75], v[116:119]
    v_mfma_f32_16x16x32_bf16 v[108:111], a[232:235], a[68:71], v[108:111]
    buffer_load_dwordx4 v18, s[44:47], s78 offen offset:0 lds
    v_mfma_f32_16x16x32_bf16 v[108:111], a[236:239], a[84:87], v[108:111]
    ds_read_b64_tr_b16 a[252:253], v29 offset:20480
    ds_read_b64_tr_b16 a[254:255], v29 offset:20992
    v_mfma_f32_16x16x32_bf16 v[100:103], a[236:239], a[80:83], v[100:103]
    s_add_u32 m0, s86, 131072
    s_add_u32 s94, s78, 7168
    v_mfma_f32_16x16x32_bf16 v[100:103], a[232:235], a[64:67], v[100:103]
    s_waitcnt lgkmcnt(4)
    v_mfma_f32_16x16x32_bf16 v[192:195], a[160:163], a[240:243], v[192:195]
    ds_read_b64_tr_b16 a[224:225], v31 offset:16384
    v_mfma_f32_16x16x32_bf16 v[192:195], a[176:179], a[244:247], v[192:195]
    buffer_load_dwordx4 v10, s[40:43], s94 offen offset:0 lds
    v_mfma_f32_16x16x32_bf16 v[196:199], a[180:183], a[244:247], v[196:199]
    ds_read_b64_tr_b16 a[226:227], v31 offset:16896
    v_mfma_f32_16x16x32_bf16 v[196:199], a[164:167], a[240:243], v[196:199]
    s_cmp_gt_u32 s3, 0
    s_cselect_b64 s[48:49], -1, 0
    v_mfma_f32_16x16x32_bf16 v[200:203], a[168:171], a[240:243], v[200:203]
    buffer_load_dwordx4 v11, s[40:43], s94 offen offset:1024 lds
    v_mfma_f32_16x16x32_bf16 v[200:203], a[184:187], a[244:247], v[200:203]
    ds_read_b64_tr_b16 a[228:229], v31 offset:20480
    ds_read_b64_tr_b16 a[230:231], v31 offset:20992
    v_mfma_f32_16x16x32_bf16 v[204:207], a[188:191], a[244:247], v[204:207]
    s_cmp_gt_u32 s3, 1
    s_cselect_b64 s[50:51], -1, 0
    v_mfma_f32_16x16x32_bf16 v[204:207], a[172:175], a[240:243], v[204:207]
    s_cmp_gt_u32 s3, 2
    s_cselect_b64 s[72:73], -1, 0
    s_waitcnt lgkmcnt(4)
    v_mfma_f32_16x16x32_bf16 v[88:91], a[248:251], a[172:175], v[88:91]
    buffer_load_dwordx4 v12, s[40:43], s94 offen offset:2048 lds
    v_mfma_f32_16x16x32_bf16 v[88:91], a[252:255], a[188:191], v[88:91]
    ds_read_b128 a[232:235], v26 offset:10240
    s_mov_b32 s74, 0
    v_mfma_f32_16x16x32_bf16 v[80:83], a[252:255], a[184:187], v[80:83]
    s_mov_b32 s75, -1
    s_mov_b32 s76, 0xffff0000
    v_mfma_f32_16x16x32_bf16 v[80:83], a[248:251], a[168:171], v[80:83]
    s_mov_b32 s77, 0xffff0000
    v_lshrrev_b32 v3, 4, v1
    v_mfma_f32_16x16x32_bf16 v[72:75], a[248:251], a[164:167], v[72:75]
    buffer_load_dwordx4 v13, s[40:43], s94 offen offset:3072 lds
    v_mfma_f32_16x16x32_bf16 v[72:75], a[252:255], a[180:183], v[72:75]
    ds_read_b128 a[236:239], v27 offset:10240
    v_lshl_add_u32 v3, v3, 1, s96
    v_mfma_f32_16x16x32_bf16 v[64:67], a[252:255], a[176:179], v[64:67]
    v_cmp_le_u32 s[44:45], 8, v3
    v_cmp_le_u32 s[46:47], 7, v3
    v_mfma_f32_16x16x32_bf16 v[64:67], a[248:251], a[160:163], v[64:67]
    s_movk_i32 s79, 7168
    s_waitcnt lgkmcnt(2)
    v_mfma_f32_16x16x32_bf16 v[68:71], a[224:227], a[160:163], v[68:71]
    ds_read_b64_tr_b16 a[240:241], v29 offset:24576
    s_waitcnt vmcnt(7)
    v_mfma_f32_16x16x32_bf16 v[68:71], a[228:231], a[176:179], v[68:71]
    ds_read_b128 a[192:195], v24 offset:0
    ds_read_b128 a[196:199], v24 offset:2048
    v_mfma_f32_16x16x32_bf16 v[76:79], a[228:231], a[180:183], v[76:79]
    ds_read_b64_tr_b16 a[242:243], v29 offset:25088
    ds_read_b128 a[208:211], v25 offset:0
    v_mfma_f32_16x16x32_bf16 v[76:79], a[224:227], a[164:167], v[76:79]
    ds_read_b128 a[212:215], v25 offset:2048
    s_movk_i32 s80, 14336
    v_mfma_f32_16x16x32_bf16 v[84:87], a[224:227], a[168:171], v[84:87]
    s_add_u32 m0, s86, 114688
    ds_read_b64_tr_b16 a[244:245], v29 offset:28672
    v_mfma_f32_16x16x32_bf16 v[84:87], a[228:231], a[184:187], v[84:87]
    ds_read_b64_tr_b16 a[246:247], v29 offset:29184
    s_movk_i32 s81, 21504
    v_mfma_f32_16x16x32_bf16 v[92:95], a[228:231], a[188:191], v[92:95]
    s_waitcnt lgkmcnt(2)
    v_mfma_f32_16x16x32_bf16 v[92:95], a[224:227], a[172:175], v[92:95]
    v_mfma_f32_16x16x32_bf16 v[220:223], a[172:175], a[232:235], v[220:223]
    buffer_load_dwordx4 v19, s[52:55], s29 offen offset:0 lds
    v_mfma_f32_16x16x32_bf16 v[220:223], a[188:191], a[236:239], v[220:223]
    ds_read_b64_tr_b16 a[248:249], v31 offset:24576
    ds_read_b64_tr_b16 a[250:251], v31 offset:25088
    v_mfma_f32_16x16x32_bf16 v[216:219], a[184:187], a[236:239], v[216:219]
    v_mfma_f32_16x16x32_bf16 v[216:219], a[168:171], a[232:235], v[216:219]
    buffer_load_dwordx4 v20, s[52:55], s29 offen offset:1024 lds
    v_mfma_f32_16x16x32_bf16 v[212:215], a[164:167], a[232:235], v[212:215]
    ds_read_b64_tr_b16 a[252:253], v31 offset:28672
    v_mfma_f32_16x16x32_bf16 v[212:215], a[180:183], a[236:239], v[212:215]
    ds_read_b64_tr_b16 a[254:255], v31 offset:29184
    v_mfma_f32_16x16x32_bf16 v[208:211], a[176:179], a[236:239], v[208:211]
    buffer_load_dwordx4 v21, s[52:55], s29 offen offset:2048 lds
    v_mfma_f32_16x16x32_bf16 v[208:211], a[160:163], a[232:235], v[208:211]
    s_waitcnt lgkmcnt(4)
    v_mfma_f32_16x16x32_bf16 v[96:99], a[240:243], a[160:163], v[96:99]
    s_waitcnt vmcnt(7)
    v_mfma_f32_16x16x32_bf16 v[96:99], a[244:247], a[176:179], v[96:99]
    s_barrier
    ds_read_b128 a[224:227], v26 offset:0
    v_mfma_f32_16x16x32_bf16 v[104:107], a[244:247], a[180:183], v[104:107]
    buffer_load_dwordx4 v22, s[52:55], s29 offen offset:3072 lds
    v_mfma_f32_16x16x32_bf16 v[104:107], a[240:243], a[164:167], v[104:107]
    v_mfma_f32_16x16x32_bf16 v[112:115], a[240:243], a[168:171], v[112:115]
    ds_read_b128 a[228:231], v27 offset:0
    v_mfma_f32_16x16x32_bf16 v[112:115], a[244:247], a[184:187], v[112:115]
    v_mfma_f32_16x16x32_bf16 v[120:123], a[244:247], a[188:191], v[120:123]
    s_waitcnt vmcnt(4)
    v_mfma_f32_16x16x32_bf16 v[120:123], a[240:243], a[172:175], v[120:123]
    ds_read_b128 a[200:203], v24 offset:16384
    s_waitcnt lgkmcnt(3)
    v_mfma_f32_16x16x32_bf16 v[124:127], a[248:251], a[172:175], v[124:127]
    ds_read_b128 a[204:207], v24 offset:18432
    ds_read_b128 a[232:235], v26 offset:2048
    v_mfma_f32_16x16x32_bf16 v[124:127], a[252:255], a[188:191], v[124:127]
    buffer_load_dword v7, v245, s[56:59], 0 offen sc1
    v_mfma_f32_16x16x32_bf16 v[116:119], a[252:255], a[184:187], v[116:119]
    ds_read_b128 a[216:219], v25 offset:16384
    ds_read_b128 a[220:223], v25 offset:18432
    v_mfma_f32_16x16x32_bf16 v[116:119], a[248:251], a[168:171], v[116:119]
    v_mfma_f32_16x16x32_bf16 v[108:111], a[248:251], a[164:167], v[108:111]
    ds_read_b128 a[236:239], v27 offset:2048
    v_mfma_f32_16x16x32_bf16 v[108:111], a[252:255], a[180:183], v[108:111]
    v_mfma_f32_16x16x32_bf16 v[100:103], a[252:255], a[176:179], v[100:103]
    s_add_u32 m0, s86, 131072
    v_mfma_f32_16x16x32_bf16 v[100:103], a[248:251], a[160:163], v[100:103]
    s_waitcnt lgkmcnt(1)
    v_mfma_f32_16x16x32_bf16 v[192:195], a[192:195], a[224:227], v[192:195]
    ds_read_b64_tr_b16 a[240:241], v29 offset:32768
    v_mfma_f32_16x16x32_bf16 v[192:195], a[208:211], a[228:231], v[192:195]
    buffer_load_dwordx4 v19, s[52:55], s30 offen offset:0 lds
    v_mfma_f32_16x16x32_bf16 v[196:199], a[212:215], a[228:231], v[196:199]
    ds_read_b64_tr_b16 a[242:243], v29 offset:33280
    v_mfma_f32_16x16x32_bf16 v[196:199], a[196:199], a[224:227], v[196:199]
    v_mfma_f32_16x16x32_bf16 v[200:203], a[200:203], a[224:227], v[200:203]
    buffer_load_dwordx4 v20, s[52:55], s30 offen offset:1024 lds
    v_mfma_f32_16x16x32_bf16 v[200:203], a[216:219], a[228:231], v[200:203]
    ds_read_b64_tr_b16 a[244:245], v29 offset:36864
    ds_read_b64_tr_b16 a[246:247], v29 offset:37376
    v_mfma_f32_16x16x32_bf16 v[204:207], a[220:223], a[228:231], v[204:207]
    v_xor_b32 v28, 64, v28
    v_xor_b32 v30, 64, v30
    v_mfma_f32_16x16x32_bf16 v[204:207], a[204:207], a[224:227], v[204:207]
    s_waitcnt lgkmcnt(4)
    v_mfma_f32_16x16x32_bf16 v[220:223], a[204:207], a[232:235], v[220:223]
    buffer_load_dwordx4 v21, s[52:55], s30 offen offset:2048 lds
    v_mfma_f32_16x16x32_bf16 v[220:223], a[220:223], a[236:239], v[220:223]
    ds_read_b64_tr_b16 a[248:249], v31 offset:32768
    ds_read_b64_tr_b16 a[250:251], v31 offset:33280
    v_mfma_f32_16x16x32_bf16 v[216:219], a[216:219], a[236:239], v[216:219]
    v_mfma_f32_16x16x32_bf16 v[216:219], a[200:203], a[232:235], v[216:219]
    v_mfma_f32_16x16x32_bf16 v[212:215], a[196:199], a[232:235], v[212:215]
    buffer_load_dwordx4 v22, s[52:55], s30 offen offset:3072 lds
    v_mfma_f32_16x16x32_bf16 v[212:215], a[212:215], a[236:239], v[212:215]
    ds_read_b64_tr_b16 a[252:253], v31 offset:36864
    ds_read_b64_tr_b16 a[254:255], v31 offset:37376
    v_mfma_f32_16x16x32_bf16 v[208:211], a[208:211], a[236:239], v[208:211]
    v_mfma_f32_16x16x32_bf16 v[208:211], a[192:195], a[232:235], v[208:211]
    s_waitcnt vmcnt(4)
    s_waitcnt lgkmcnt(4)
    v_mfma_f32_16x16x32_bf16 v[64:67], a[240:243], a[192:195], v[64:67]
    ds_read_b64_tr_b16 a[224:225], v29 offset:40960
    v_xor_b32 v7, v37, v7
    v_mfma_f32_16x16x32_bf16 v[64:67], a[244:247], a[208:211], v[64:67]
    ds_read_b64_tr_b16 a[226:227], v29 offset:41472
    v_cmp_ne_u32 vcc, 0, v7
    v_mfma_f32_16x16x32_bf16 v[72:75], a[244:247], a[212:215], v[72:75]
    s_nop 0
    s_cbranch_vccnz L_slow_c
L_back_c:
    v_mfma_f32_16x16x32_bf16 v[72:75], a[240:243], a[196:199], v[72:75]
    buffer_load_dword v254, v244, s[56:59], 0 offen sc1
    v_mfma_f32_16x16x32_bf16 v[80:83], a[240:243], a[200:203], v[80:83]
    ds_read_b64_tr_b16 a[228:229], v29 offset:45056
    v_fma_f32 v4, v40, v192, v193
    v_mfma_f32_16x16x32_bf16 v[80:83], a[244:247], a[216:219], v[80:83]
    buffer_load_dwordx4 v[128:131], v23, s[68:71], s22 offen offset:0 sc1
    v_mfma_f32_16x16x32_bf16 v[88:91], a[244:247], a[220:223], v[88:91]
    ds_read_b64_tr_b16 a[230:231], v29 offset:45568
    v_fma_f32 v5, v40, v208, v209
    v_mfma_f32_16x16x32_bf16 v[88:91], a[240:243], a[204:207], v[88:91]
    v_fmac_f32 v4, v42, v208
    s_waitcnt lgkmcnt(4)
    v_mfma_f32_16x16x32_bf16 v[92:95], a[248:251], a[204:207], v[92:95]
    ds_read_b64_tr_b16 a[232:233], v31 offset:40960
    v_fmac_f32 v5, v41, v192
    v_mfma_f32_16x16x32_bf16 v[92:95], a[252:255], a[220:223], v[92:95]
    buffer_load_dwordx4 v[132:135], v23, s[68:71], s22 offen offset:1024 sc1
    v_mfma_f32_16x16x32_bf16 v[84:87], a[252:255], a[216:219], v[84:87]
    ds_read_b64_tr_b16 a[234:235], v31 offset:41472
    v_fma_f32 v2, v40, v4, v194
    v_mfma_f32_16x16x32_bf16 v[84:87], a[248:251], a[200:203], v[84:87]
    v_fma_f32 v3, v40, v5, v210
    v_fmac_f32 v2, v42, v5
    v_mfma_f32_16x16x32_bf16 v[76:79], a[248:251], a[196:199], v[76:79]
    buffer_load_dwordx4 v[136:139], v23, s[68:71], s22 offen offset:2048 sc1
    v_mfma_f32_16x16x32_bf16 v[76:79], a[252:255], a[212:215], v[76:79]
    ds_read_b64_tr_b16 a[236:237], v31 offset:45056
    ds_read_b64_tr_b16 a[238:239], v31 offset:45568
    v_fmac_f32 v3, v41, v4
    v_fma_f32 v4, v40, v2, v195
    v_fma_f32 v5, v40, v3, v211
    v_fmac_f32 v4, v42, v3
    v_mfma_f32_16x16x32_bf16 v[68:71], a[252:255], a[208:211], v[68:71]
    v_fmac_f32 v5, v41, v2
    v_fma_f32 v2, v40, v4, v196
    v_fma_f32 v3, v40, v5, v212
    v_fmac_f32 v2, v42, v5
    v_mfma_f32_16x16x32_bf16 v[68:71], a[248:251], a[192:195], v[68:71]
    v_fmac_f32 v3, v41, v4
    v_fma_f32 v4, v40, v2, v197
    v_fma_f32 v5, v40, v3, v213
    v_fmac_f32 v4, v42, v3
    s_waitcnt lgkmcnt(4)
    v_mfma_f32_16x16x32_bf16 v[96:99], a[224:227], a[192:195], v[96:99]
    buffer_load_dwordx4 v[140:143], v23, s[68:71], s22 offen offset:3072 sc1
    v_fmac_f32 v5, v41, v2
    v_fma_f32 v2, v40, v4, v198
    v_fma_f32 v3, v40, v5, v214
    v_fmac_f32 v2, v42, v5
    v_mfma_f32_16x16x32_bf16 v[96:99], a[228:231], a[208:211], v[96:99]
    ds_read_b64_tr_b16 a[240:241], v28 offset:0
    ds_read_b64_tr_b16 a[242:243], v28 offset:512
    v_fmac_f32 v3, v41, v4
    v_fma_f32 v4, v40, v2, v199
    v_fma_f32 v5, v40, v3, v215
    v_fmac_f32 v4, v42, v3
    v_mfma_f32_16x16x32_bf16 v[104:107], a[228:231], a[212:215], v[104:107]
    v_fmac_f32 v5, v41, v2
    v_fma_f32 v2, v40, v4, v200
    v_fma_f32 v3, v40, v5, v216
    v_fmac_f32 v2, v42, v5
    v_mfma_f32_16x16x32_bf16 v[104:107], a[224:227], a[196:199], v[104:107]
    buffer_load_dwordx4 v[144:147], v23, s[68:71], s23 offen offset:0 sc1
    v_fmac_f32 v3, v41, v4
    v_fma_f32 v4, v40, v2, v201
    v_fma_f32 v5, v40, v3, v217
    v_fmac_f32 v4, v42, v3
    v_fmac_f32 v5, v41, v2
    v_mfma_f32_16x16x32_bf16 v[112:115], a[224:227], a[200:203], v[112:115]
    ds_read_b64_tr_b16 a[244:245], v28 offset:4096
    v_fma_f32 v2, v40, v4, v202
    v_fma_f32 v3, v40, v5, v218
    v_fmac_f32 v2, v42, v5
    v_fmac_f32 v3, v41, v4
    v_mfma_f32_16x16x32_bf16 v[112:115], a[228:231], a[216:219], v[112:115]
    ds_read_b64_tr_b16 a[246:247], v28 offset:4608
    v_fma_f32 v4, v40, v2, v203
    v_fma_f32 v5, v40, v3, v219
    v_fmac_f32 v4, v42, v3
    v_fmac_f32 v5, v41, v2
    v_mfma_f32_16x16x32_bf16 v[120:123], a[228:231], a[220:223], v[120:123]
    buffer_load_dwordx4 v[148:151], v23, s[68:71], s23 offen offset:1024 sc1
    v_fma_f32 v2, v40, v4, v204
    v_fma_f32 v3, v40, v5, v220
    v_fmac_f32 v2, v42, v5
    v_fmac_f32 v3, v41, v4
    v_mfma_f32_16x16x32_bf16 v[120:123], a[224:227], a[204:207], v[120:123]
    v_fma_f32 v4, v40, v2, v205
    v_fma_f32 v5, v40, v3, v221
    v_fmac_f32 v4, v42, v3
    v_fmac_f32 v5, v41, v2
    s_waitcnt lgkmcnt(4)
    v_mfma_f32_16x16x32_bf16 v[124:127], a[232:235], a[204:207], v[124:127]
    ds_read_b64_tr_b16 a[248:249], v30 offset:0
    v_fma_f32 v2, v40, v4, v206
    v_fma_f32 v3, v40, v5, v222
    v_fmac_f32 v2, v42, v5
    v_fmac_f32 v3, v41, v4
    v_fma_f32 v60, v40, v2, v207
    v_mfma_f32_16x16x32_bf16 v[124:127], a[236:239], a[220:223], v[124:127]
    buffer_load_dwordx4 v[152:155], v23, s[68:71], s23 offen offset:2048 sc1
    v_fma_f32 v61, v40, v3, v223
    v_fmac_f32 v60, v42, v3
    v_fmac_f32 v61, v41, v2
    v_mov_b32 v62, v60
    v_mfma_f32_16x16x32_bf16 v[116:119], a[236:239], a[216:219], v[116:119]
    ds_read_b64_tr_b16 a[250:251], v30 offset:512
    v_mov_b32 v63, v61
    v_permlane16_swap_b32 v60, v62
    s_nop 0
    v_permlane16_swap_b32 v61, v63
    v_fmac_f32 v62, v43, v60
    v_mfma_f32_16x16x32_bf16 v[116:119], a[232:235], a[200:203], v[116:119]
    v_fmac_f32 v63, v43, v61
    v_fma_f32 v62, -v44, v61, v62
    v_fmac_f32 v63, v44, v60
    v_mov_b32 v2, v62
    v_mfma_f32_16x16x32_bf16 v[108:111], a[232:235], a[196:199], v[108:111]
    ds_read_b64_tr_b16 a[252:253], v30 offset:4096
    v_mov_b32 v3, v63
    v_permlane32_swap_b32 v62, v2
    s_nop 0
    v_permlane32_swap_b32 v63, v3
    v_fmac_f32 v2, v45, v62
    v_mfma_f32_16x16x32_bf16 v[108:111], a[236:239], a[212:215], v[108:111]
    buffer_load_dwordx4 v[156:159], v23, s[68:71], s23 offen offset:3072 sc1
    v_fmac_f32 v3, v45, v63
    v_fma_f32 v2, -v46, v63, v2
    v_fmac_f32 v3, v46, v62
    ds_write_b64 v246, v[2:3]
    v_mfma_f32_16x16x32_bf16 v[100:103], a[236:239], a[208:211], v[100:103]
    ds_read_b64_tr_b16 a[254:255], v30 offset:4608
    v_mfma_f32_16x16x32_bf16 v[100:103], a[232:235], a[192:195], v[100:103]
    s_waitcnt vmcnt(8)
    v_sub_f32 v14, 1.0, v254
    v_sub_f32 v15, 1.0, v254
    s_nop 1
    v_permlane16_swap_b32 v14, v15
    v_mov_b32 v16, v14
    v_mov_b32 v17, v15
    s_nop 0
    v_permlane32_swap_b32 v14, v16
    v_permlane32_swap_b32 v15, v17
    v_pk_mul_f32 v[64:65], v[64:65], v[14:15] op_sel_hi:[1,0]
    v_pk_mul_f32 v[66:67], v[66:67], v[14:15] op_sel_hi:[1,0]
    v_pk_mul_f32 v[68:69], v[68:69], v[14:15] op_sel_hi:[1,0]
    v_pk_mul_f32 v[70:71], v[70:71], v[14:15] op_sel_hi:[1,0]
    v_pk_mul_f32 v[64:65], v[64:65], v[96:97]
    v_pk_mul_f32 v[66:67], v[66:67], v[98:99]
    v_pk_mul_f32 v[68:69], v[68:69], v[100:101]
    v_pk_mul_f32 v[70:71], v[70:71], v[102:103]
    v_cvt_pk_bf16_f32 v96, v64, v65
    v_cvt_pk_bf16_f32 v97, v66, v67
    v_cvt_pk_bf16_f32 v98, v68, v69
    v_cvt_pk_bf16_f32 v99, v70, v71
    buffer_store_dwordx4 v[96:99], v23, s[56:59], s87 offen offset:0 sc1
    s_waitcnt lgkmcnt(1)
    s_barrier
    ds_write_b32 v247, v254
    ds_read_b128 v[2:5], v59
    ds_read_b128 v[6:9], v59 offset:16
    v_pk_mul_f32 v[72:73], v[72:73], v[14:15] op_sel:[0,1] op_sel_hi:[1,1]
    v_pk_mul_f32 v[74:75], v[74:75], v[14:15] op_sel:[0,1] op_sel_hi:[1,1]
    v_pk_mul_f32 v[76:77], v[76:77], v[14:15] op_sel:[0,1] op_sel_hi:[1,1]
    v_pk_mul_f32 v[78:79], v[78:79], v[14:15] op_sel:[0,1] op_sel_hi:[1,1]
    v_pk_mul_f32 v[72:73], v[72:73], v[104:105]
    v_pk_mul_f32 v[74:75], v[74:75], v[106:107]
    v_pk_mul_f32 v[76:77], v[76:77], v[108:109]
    v_pk_mul_f32 v[78:79], v[78:79], v[110:111]
    v_cvt_pk_bf16_f32 v104, v72, v73
    v_cvt_pk_bf16_f32 v105, v74, v75
    v_cvt_pk_bf16_f32 v106, v76, v77
    v_cvt_pk_bf16_f32 v107, v78, v79
    buffer_store_dwordx4 v[104:107], v23, s[56:59], s87 offen offset:1024 sc1
    v_pk_mul_f32 v[80:81], v[80:81], v[16:17] op_sel_hi:[1,0]
    v_pk_mul_f32 v[82:83], v[82:83], v[16:17] op_sel_hi:[1,0]
    v_pk_mul_f32 v[84:85], v[84:85], v[16:17] op_sel_hi:[1,0]
    v_pk_mul_f32 v[86:87], v[86:87], v[16:17] op_sel_hi:[1,0]
    v_pk_mul_f32 v[80:81], v[80:81], v[112:113]
    v_pk_mul_f32 v[82:83], v[82:83], v[114:115]
    v_pk_mul_f32 v[84:85], v[84:85], v[116:117]
    v_pk_mul_f32 v[86:87], v[86:87], v[118:119]
    v_cvt_pk_bf16_f32 v112, v80, v81
    v_cvt_pk_bf16_f32 v113, v82, v83
    v_cvt_pk_bf16_f32 v114, v84, v85
    v_cvt_pk_bf16_f32 v115, v86, v87
    buffer_store_dwordx4 v[112:115], v23, s[56:59], s87 offen offset:2048 sc1
    s_waitcnt lgkmcnt(0)
    v_fmac_f32 v4, v47, v2
    v_fmac_f32 v5, v47, v3
    v_fma_f32 v4, -v48, v3, v4
    v_fmac_f32 v5, v48, v2
    v_fmac_f32 v6, v47, v4
    v_fmac_f32 v7, v47, v5
    v_fma_f32 v6, -v48, v5, v6
    v_fmac_f32 v7, v48, v4
    v_fma_f32 v36, v47, v6, v8
    v_fma_f32 v38, v47, v7, v9
    v_fma_f32 v36, -v48, v7, v36
    v_fmac_f32 v38, v48, v6
    s_cmp_lg_u32 s3, 0
    s_cbranch_scc1 L_nost
    buffer_store_dwordx4 v[36:39], v235, s[56:59], 0 offen sc1
L_nost:
    v_pk_mul_f32 v[88:89], v[88:89], v[16:17] op_sel:[0,1] op_sel_hi:[1,1]
    v_pk_mul_f32 v[90:91], v[90:91], v[16:17] op_sel:[0,1] op_sel_hi:[1,1]
    v_pk_mul_f32 v[92:93], v[92:93], v[16:17] op_sel:[0,1] op_sel_hi:[1,1]
    v_pk_mul_f32 v[94:95], v[94:95], v[16:17] op_sel:[0,1] op_sel_hi:[1,1]
    v_pk_mul_f32 v[88:89], v[88:89], v[120:121]
    v_pk_mul_f32 v[90:91], v[90:91], v[122:123]
    v_pk_mul_f32 v[92:93], v[92:93], v[124:125]
    v_pk_mul_f32 v[94:95], v[94:95], v[126:127]
    v_cvt_pk_bf16_f32 v120, v88, v89
    v_cvt_pk_bf16_f32 v121, v90, v91
    v_cvt_pk_bf16_f32 v122, v92, v93
    v_cvt_pk_bf16_f32 v123, v94, v95
    buffer_store_dwordx4 v[120:123], v23, s[56:59], s87 offen offset:3072 sc1
    v_mfma_f32_16x16x32_bf16 v[64:67], a[240:243], a[0:3], 0
    ds_read_b64_tr_b16 a[224:225], v28 offset:8192
    v_cndmask_b32 v2, 0, v2, s[48:49]
    v_mfma_f32_16x16x32_bf16 v[64:67], a[244:247], a[16:19], v[64:67]
    ds_read_b64_tr_b16 a[226:227], v28 offset:8704
    v_cndmask_b32 v3, 0, v3, s[48:49]
    v_mfma_f32_16x16x32_bf16 v[72:75], a[244:247], a[20:23], 0
    v_cndmask_b32 v2, v2, v4, s[50:51]
    v_cndmask_b32 v3, v3, v5, s[50:51]
    v_mfma_f32_16x16x32_bf16 v[72:75], a[240:243], a[4:7], v[72:75]
    v_cndmask_b32 v2, v2, v6, s[72:73]
    v_cndmask_b32 v3, v3, v7, s[72:73]
    v_mfma_f32_16x16x32_bf16 v[80:83], a[240:243], a[8:11], 0
    ds_read_b64_tr_b16 a[228:229], v28 offset:12288
    v_fmac_f32 v62, v45, v2
    v_mfma_f32_16x16x32_bf16 v[80:83], a[244:247], a[24:27], v[80:83]
    ds_read_b64_tr_b16 a[230:231], v28 offset:12800
    v_fmac_f32 v63, v45, v3
    v_mfma_f32_16x16x32_bf16 v[88:91], a[244:247], a[28:31], 0
    v_fma_f32 v62, -v46, v3, v62
    v_fmac_f32 v63, v46, v2
    v_mfma_f32_16x16x32_bf16 v[88:91], a[240:243], a[12:15], v[88:91]
    v_cndmask_b32 v2, v2, v62, s[74:75]
    v_mfma_f32_16x16x32_bf16 v[92:95], a[248:251], a[12:15], 0
    ds_read_b64_tr_b16 a[232:233], v30 offset:8192
    v_cndmask_b32 v3, v3, v63, s[74:75]
    v_mfma_f32_16x16x32_bf16 v[92:95], a[252:255], a[28:31], v[92:95]
    ds_read_b64_tr_b16 a[234:235], v30 offset:8704
    v_fmac_f32 v60, v43, v2
    v_mfma_f32_16x16x32_bf16 v[84:87], a[252:255], a[24:27], 0
    v_fmac_f32 v61, v43, v3
    v_fma_f32 v60, -v44, v3, v60
    v_mfma_f32_16x16x32_bf16 v[84:87], a[248:251], a[8:11], v[84:87]
    v_fmac_f32 v61, v44, v2
    v_cndmask_b32 v2, v2, v60, s[76:77]
    v_mfma_f32_16x16x32_bf16 v[76:79], a[248:251], a[4:7], 0
    ds_read_b64_tr_b16 a[236:237], v30 offset:12288
    v_cndmask_b32 v3, v3, v61, s[76:77]
    v_mfma_f32_16x16x32_bf16 v[76:79], a[252:255], a[20:23], v[76:79]
    ds_read_b64_tr_b16 a[238:239], v30 offset:12800
    v_mul_f32 v60, v55, v2
    v_mfma_f32_16x16x32_bf16 v[68:71], a[252:255], a[16:19], 0
    v_mul_f32 v61, v55, v3
    v_fma_f32 v60, -v56, v3, v60
    v_mfma_f32_16x16x32_bf16 v[68:71], a[248:251], a[0:3], v[68:71]
    v_fmac_f32 v61, v56, v2
    s_waitcnt lgkmcnt(4)
    v_mfma_f32_16x16x32_bf16 v[96:99], a[224:227], a[0:3], 0
    ds_read_b64_tr_b16 a[240:241], v28 offset:16384
    v_xor_b32 v29, 64, v29
    v_mfma_f32_16x16x32_bf16 v[96:99], a[228:231], a[16:19], v[96:99]
    ds_read_b64_tr_b16 a[242:243], v28 offset:16896
    v_xor_b32 v31, 64, v31
    v_mfma_f32_16x16x32_bf16 v[104:107], a[228:231], a[20:23], 0
    v_mul_f32 v59, v55, v192
    v_fma_f32 v59, -v56, v208, v59
    v_mfma_f32_16x16x32_bf16 v[104:107], a[224:227], a[4:7], v[104:107]
    v_mul_f32 v208, v55, v208
    v_fmac_f32 v208, v56, v192
    v_mfma_f32_16x16x32_bf16 v[112:115], a[224:227], a[8:11], 0
    ds_read_b64_tr_b16 a[244:245], v28 offset:20480
    v_mul_f32 v192, v55, v193
    v_mfma_f32_16x16x32_bf16 v[112:115], a[228:231], a[24:27], v[112:115]
    ds_read_b64_tr_b16 a[246:247], v28 offset:20992
    v_fma_f32 v192, -v56, v209, v192
    v_mfma_f32_16x16x32_bf16 v[120:123], a[228:231], a[28:31], 0
    v_mul_f32 v209, v55, v209
    v_fmac_f32 v209, v56, v193
    v_mfma_f32_16x16x32_bf16 v[120:123], a[224:227], a[12:15], v[120:123]
    v_mul_f32 v193, v55, v194
    s_waitcnt lgkmcnt(4)
    v_mfma_f32_16x16x32_bf16 v[124:127], a[232:235], a[12:15], 0
    s_add_u32 m0, s86, 0
    s_barrier
    v_mfma_f32_16x16x32_bf16 v[124:127], a[236:239], a[28:31], v[124:127]
    ds_read_b64_tr_b16 a[248:249], v30 offset:16384
    ds_read_b64_tr_b16 a[250:251], v30 offset:16896
    v_mfma_f32_16x16x32_bf16 v[116:119], a[236:239], a[24:27], 0
    v_fma_f32 v193, -v56, v210, v193
    v_mul_f32 v210, v55, v210
    v_mfma_f32_16x16x32_bf16 v[116:119], a[232:235], a[8:11], v[116:119]
    buffer_load_dwordx4 v19, s[52:55], s31 offen offset:0 lds
    v_mfma_f32_16x16x32_bf16 v[108:111], a[232:235], a[4:7], 0
    ds_read_b64_tr_b16 a[252:253], v30 offset:20480
    v_fmac_f32 v210, v56, v194
    v_mfma_f32_16x16x32_bf16 v[108:111], a[236:239], a[20:23], v[108:111]
    ds_read_b64_tr_b16 a[254:255], v30 offset:20992
    v_mul_f32 v194, v55, v195
    v_mfma_f32_16x16x32_bf16 v[100:103], a[236:239], a[16:19], 0
    v_fma_f32 v194, -v56, v211, v194
    v_mul_f32 v211, v55, v211
    v_mfma_f32_16x16x32_bf16 v[100:103], a[232:235], a[0:3], v[100:103]
    v_fmac_f32 v211, v56, v195
    s_waitcnt lgkmcnt(4)
    v_mfma_f32_16x16x32_bf16 v[64:67], a[240:243], a[32:35], v[64:67]
    buffer_load_dwordx4 v20, s[52:55], s31 offen offset:1024 lds
    v_mfma_f32_16x16x32_bf16 v[64:67], a[244:247], a[48:51], v[64:67]
    ds_read_b64_tr_b16 a[224:225], v28 offset:24576
    ds_read_b64_tr_b16 a[226:227], v28 offset:25088
    v_mfma_f32_16x16x32_bf16 v[72:75], a[244:247], a[52:55], v[72:75]
    v_mul_f32 v195, v55, v196
    v_fma_f32 v195, -v56, v212, v195
    v_mfma_f32_16x16x32_bf16 v[72:75], a[240:243], a[36:39], v[72:75]
    buffer_load_dwordx4 v21, s[52:55], s31 offen offset:2048 lds
    v_mfma_f32_16x16x32_bf16 v[80:83], a[240:243], a[40:43], v[80:83]
    ds_read_b64_tr_b16 a[228:229], v28 offset:28672
    v_mul_f32 v212, v55, v212
    v_mfma_f32_16x16x32_bf16 v[80:83], a[244:247], a[56:59], v[80:83]
    ds_read_b64_tr_b16 a[230:231], v28 offset:29184
    v_fmac_f32 v212, v56, v196
    v_mfma_f32_16x16x32_bf16 v[88:91], a[244:247], a[60:63], v[88:91]
    v_mul_f32 v196, v55, v197
    v_fma_f32 v196, -v56, v213, v196
    v_mfma_f32_16x16x32_bf16 v[88:91], a[240:243], a[44:47], v[88:91]
    v_mul_f32 v213, v55, v213
    s_waitcnt lgkmcnt(4)
    v_mfma_f32_16x16x32_bf16 v[92:95], a[248:251], a[44:47], v[92:95]
    buffer_load_dwordx4 v22, s[52:55], s31 offen offset:3072 lds
    v_mfma_f32_16x16x32_bf16 v[92:95], a[252:255], a[60:63], v[92:95]
    ds_read_b64_tr_b16 a[232:233], v30 offset:24576
    ds_read_b64_tr_b16 a[234:235], v30 offset:25088
    v_mfma_f32_16x16x32_bf16 v[84:87], a[252:255], a[56:59], v[84:87]
    v_fmac_f32 v213, v56, v197
    v_mul_f32 v197, v55, v198
    v_mfma_f32_16x16x32_bf16 v[84:87], a[248:251], a[40:43], v[84:87]
    buffer_load_dwordx4 v[160:163], v23, s[68:71], s24 offen offset:0 sc1
    v_mfma_f32_16x16x32_bf16 v[76:79], a[248:251], a[36:39], v[76:79]
    ds_read_b64_tr_b16 a[236:237], v30 offset:28672
    v_fma_f32 v197, -v56, v214, v197
    v_mfma_f32_16x16x32_bf16 v[76:79], a[252:255], a[52:55], v[76:79]
    ds_read_b64_tr_b16 a[238:239], v30 offset:29184
    v_mul_f32 v214, v55, v214
    v_mfma_f32_16x16x32_bf16 v[68:71], a[252:255], a[48:51], v[68:71]
    v_fmac_f32 v214, v56, v198
    v_mul_f32 v198, v55, v199
    v_mfma_f32_16x16x32_bf16 v[68:71], a[248:251], a[32:35], v[68:71]
    v_fma_f32 v198, -v56, v215, v198
    s_waitcnt lgkmcnt(4)
    v_mfma_f32_16x16x32_bf16 v[96:99], a[224:227], a[32:35], v[96:99]
    buffer_load_dwordx4 v[164:167], v23, s[68:71], s24 offen offset:1024 sc1
    v_mfma_f32_16x16x32_bf16 v[96:99], a[228:231], a[48:51], v[96:99]
    ds_read_b64_tr_b16 a[240:241], v28 offset:32768
    ds_read_b64_tr_b16 a[242:243], v28 offset:33280
    v_mfma_f32_16x16x32_bf16 v[104:107], a[228:231], a[52:55], v[104:107]
    s_waitcnt vmcnt(6)
    s_atomic_swap s38, s[36:37], s88 offset:0
    v_mfma_f32_16x16x32_bf16 v[104:107], a[224:227], a[36:39], v[104:107]
    buffer_load_dwordx4 v[168:171], v23, s[68:71], s24 offen offset:2048 sc1
    v_mfma_f32_16x16x32_bf16 v[112:115], a[224:227], a[40:43], v[112:115]
    ds_read_b64_tr_b16 a[244:245], v28 offset:36864
    v_mul_f32 v215, v55, v215
    v_mfma_f32_16x16x32_bf16 v[112:115], a[228:231], a[56:59], v[112:115]
    ds_read_b64_tr_b16 a[246:247], v28 offset:37376
    v_fmac_f32 v215, v56, v199
    v_mfma_f32_16x16x32_bf16 v[120:123], a[228:231], a[60:63], v[120:123]
    v_mul_f32 v199, v55, v200
    v_fma_f32 v199, -v56, v216, v199
    v_mfma_f32_16x16x32_bf16 v[120:123], a[224:227], a[44:47], v[120:123]
L_page2:
    s_cmp_eq_u32 s0, 1
    s_cbranch_scc1 L_warm
    v_mul_f32 v216, v55, v216
    s_waitcnt lgkmcnt(4)
    v_mfma_f32_16x16x32_bf16 v[124:127], a[232:235], a[44:47], v[124:127]
    buffer_load_dwordx4 v[172:175], v23, s[68:71], s24 offen offset:3072 sc1
    s_barrier
    v_mfma_f32_16x16x32_bf16 v[124:127], a[236:239], a[60:63], v[124:127]
    s_add_u32 m0, s86, 16384
    ds_read_b64_tr_b16 a[248:249], v30 offset:32768
    v_mfma_f32_16x16x32_bf16 v[116:119], a[236:239], a[56:59], v[116:119]
    ds_read_b64_tr_b16 a[250:251], v30 offset:33280
    v_fmac_f32 v216, v56, v200
    v_mfma_f32_16x16x32_bf16 v[116:119], a[232:235], a[40:43], v[116:119]
    buffer_load_dwordx4 v19, s[52:55], s32 offen offset:0 lds
    v_mfma_f32_16x16x32_bf16 v[108:111], a[232:235], a[36:39], v[108:111]
    ds_read_b64_tr_b16 a[252:253], v30 offset:36864
    v_mul_f32 v200, v55, v201
    v_mfma_f32_16x16x32_bf16 v[108:111], a[236:239], a[52:55], v[108:111]
    ds_read_b64_tr_b16 a[254:255], v30 offset:37376
    v_fma_f32 v200, -v56, v217, v200
    v_mfma_f32_16x16x32_bf16 v[100:103], a[236:239], a[48:51], v[100:103]
    v_mul_f32 v217, v55, v217
    v_fmac_f32 v217, v56, v201
    v_mfma_f32_16x16x32_bf16 v[100:103], a[232:235], a[32:35], v[100:103]
    v_mul_f32 v201, v55, v202
    s_waitcnt lgkmcnt(4)
    v_mfma_f32_16x16x32_bf16 v[64:67], a[240:243], a[64:67], v[64:67]
    buffer_load_dwordx4 v20, s[52:55], s32 offen offset:1024 lds
    v_mfma_f32_16x16x32_bf16 v[64:67], a[244:247], a[80:83], v[64:67]
    ds_read_b64_tr_b16 a[224:225], v28 offset:40960
    ds_read_b64_tr_b16 a[226:227], v28 offset:41472
    v_mfma_f32_16x16x32_bf16 v[72:75], a[244:247], a[84:87], v[72:75]
    v_fma_f32 v201, -v56, v218, v201
    v_mul_f32 v218, v55, v218
    v_mfma_f32_16x16x32_bf16 v[72:75], a[240:243], a[68:71], v[72:75]
    buffer_load_dwordx4 v21, s[52:55], s32 offen offset:2048 lds
    v_mfma_f32_16x16x32_bf16 v[80:83], a[240:243], a[72:75], v[80:83]
    ds_read_b64_tr_b16 a[228:229], v28 offset:45056
    v_fmac_f32 v218, v56, v202
    v_mfma_f32_16x16x32_bf16 v[80:83], a[244:247], a[88:91], v[80:83]
    ds_read_b64_tr_b16 a[230:231], v28 offset:45568
    v_mul_f32 v202, v55, v203
    v_mfma_f32_16x16x32_bf16 v[88:91], a[244:247], a[92:95], v[88:91]
    v_fma_f32 v202, -v56, v219, v202
    v_mul_f32 v219, v55, v219
    v_mfma_f32_16x16x32_bf16 v[88:91], a[240:243], a[76:79], v[88:91]
    v_fmac_f32 v219, v56, v203
    s_waitcnt lgkmcnt(4)
    v_mfma_f32_16x16x32_bf16 v[92:95], a[248:251], a[76:79], v[92:95]
    buffer_load_dwordx4 v22, s[52:55], s32 offen offset:3072 lds
    v_mfma_f32_16x16x32_bf16 v[92:95], a[252:255], a[92:95], v[92:95]
    ds_read_b64_tr_b16 a[232:233], v30 offset:40960
    ds_read_b64_tr_b16 a[234:235], v30 offset:41472
    v_mfma_f32_16x16x32_bf16 v[84:87], a[252:255], a[88:91], v[84:87]
    v_mul_f32 v203, v55, v204
    v_fma_f32 v203, -v56, v220, v203
    v_mfma_f32_16x16x32_bf16 v[84:87], a[248:251], a[72:75], v[84:87]
    buffer_load_dwordx4 v[176:179], v23, s[68:71], s25 offen offset:0 sc1
    v_mfma_f32_16x16x32_bf16 v[76:79], a[248:251], a[68:71], v[76:79]
    ds_read_b64_tr_b16 a[236:237], v30 offset:45056
    v_mul_f32 v220, v55, v220
    v_mfma_f32_16x16x32_bf16 v[76:79], a[252:255], a[84:87], v[76:79]
    ds_read_b64_tr_b16 a[238:239], v30 offset:45568
    v_fmac_f32 v220, v56, v204
    v_mfma_f32_16x16x32_bf16 v[68:71], a[252:255], a[80:83], v[68:71]
    v_mul_f32 v204, v55, v205
    v_fma_f32 v204, -v56, v221, v204
    v_mfma_f32_16x16x32_bf16 v[68:71], a[248:251], a[64:67], v[68:71]
    v_mul_f32 v221, v55, v221
    s_waitcnt lgkmcnt(4)
    v_mfma_f32_16x16x32_bf16 v[96:99], a[224:227], a[64:67], v[96:99]
    buffer_load_dwordx4 v[180:183], v23, s[68:71], s25 offen offset:1024 sc1
    v_mfma_f32_16x16x32_bf16 v[96:99], a[228:231], a[80:83], v[96:99]
    ds_read_b64_tr_b16 a[240:241], v28 offset:49152
    ds_read_b64_tr_b16 a[242:243], v28 offset:49664
    v_mfma_f32_16x16x32_bf16 v[104:107], a[228:231], a[84:87], v[104:107]
    v_fmac_f32 v221, v56, v205
    v_mul_f32 v205, v55, v206
    v_mfma_f32_16x16x32_bf16 v[104:107], a[224:227], a[68:71], v[104:107]
    buffer_load_dwordx4 v[184:187], v23, s[68:71], s25 offen offset:2048 sc1
    v_mfma_f32_16x16x32_bf16 v[112:115], a[224:227], a[72:75], v[112:115]
    ds_read_b64_tr_b16 a[244:245], v28 offset:53248
    v_fma_f32 v205, -v56, v222, v205
    v_mfma_f32_16x16x32_bf16 v[112:115], a[228:231], a[88:91], v[112:115]
    ds_read_b64_tr_b16 a[246:247], v28 offset:53760
    v_mul_f32 v222, v55, v222
    v_mfma_f32_16x16x32_bf16 v[120:123], a[228:231], a[92:95], v[120:123]
    v_fmac_f32 v222, v56, v206
    v_mul_f32 v206, v55, v207
    v_mfma_f32_16x16x32_bf16 v[120:123], a[224:227], a[76:79], v[120:123]
    v_fma_f32 v206, -v56, v223, v206
    s_waitcnt lgkmcnt(4)
    v_mfma_f32_16x16x32_bf16 v[124:127], a[232:235], a[76:79], v[124:127]
    buffer_load_dwordx4 v[188:191], v23, s[68:71], s25 offen offset:3072 sc1
    s_barrier
    v_mfma_f32_16x16x32_bf16 v[124:127], a[236:239], a[92:95], v[124:127]
    s_add_u32 m0, s86, 32768
    ds_read_b64_tr_b16 a[248:249], v30 offset:49152
    v_mfma_f32_16x16x32_bf16 v[116:119], a[236:239], a[88:91], v[116:119]
    ds_read_b64_tr_b16 a[250:251], v30 offset:49664
    v_mul_f32 v223, v55, v223
    v_mfma_f32_16x16x32_bf16 v[116:119], a[232:235], a[72:75], v[116:119]
    buffer_load_dwordx4 v19, s[52:55], s33 offen offset:0 lds
    v_mfma_f32_16x16x32_bf16 v[108:111], a[232:235], a[68:71], v[108:111]
    ds_read_b64_tr_b16 a[252:253], v30 offset:53248
    v_fmac_f32 v223, v56, v207
    v_mfma_f32_16x16x32_bf16 v[108:111], a[236:239], a[84:87], v[108:111]
    ds_read_b64_tr_b16 a[254:255], v30 offset:53760
    v_mfma_f32_16x16x32_bf16 v[100:103], a[236:239], a[80:83], v[100:103]
    v_mfma_f32_16x16x32_bf16 v[100:103], a[232:235], a[64:67], v[100:103]
    s_waitcnt lgkmcnt(4)
    v_mfma_f32_16x16x32_bf16 v[64:67], a[240:243], a[96:99], v[64:67]
    buffer_load_dwordx4 v20, s[52:55], s33 offen offset:1024 lds
    v_mfma_f32_16x16x32_bf16 v[64:67], a[244:247], a[112:115], v[64:67]
    ds_read_b64_tr_b16 a[224:225], v28 offset:57344
    ds_read_b64_tr_b16 a[226:227], v28 offset:57856
    v_mfma_f32_16x16x32_bf16 v[72:75], a[244:247], a[116:119], v[72:75]
    v_mfma_f32_16x16x32_bf16 v[72:75], a[240:243], a[100:103], v[72:75]
    buffer_load_dwordx4 v21, s[52:55], s33 offen offset:2048 lds
    v_mfma_f32_16x16x32_bf16 v[80:83], a[240:243], a[104:107], v[80:83]
    ds_read_b64_tr_b16 a[228:229], v28 offset:61440
    v_mfma_f32_16x16x32_bf16 v[80:83], a[244:247], a[120:123], v[80:83]
    ds_read_b64_tr_b16 a[230:231], v28 offset:61952
    v_mfma_f32_16x16x32_bf16 v[88:91], a[244:247], a[124:127], v[88:91]
    v_mfma_f32_16x16x32_bf16 v[88:91], a[240:243], a[108:111], v[88:91]
    s_waitcnt lgkmcnt(4)
    v_mfma_f32_16x16x32_bf16 v[92:95], a[248:251], a[108:111], v[92:95]
    buffer_load_dwordx4 v22, s[52:55], s33 offen offset:3072 lds
    v_mfma_f32_16x16x32_bf16 v[92:95], a[252:255], a[124:127], v[92:95]
    ds_read_b64_tr_b16 a[232:233], v30 offset:57344
    ds_read_b64_tr_b16 a[234:235], v30 offset:57856
    v_mfma_f32_16x16x32_bf16 v[84:87], a[252:255], a[120:123], v[84:87]
    v_mfma_f32_16x16x32_bf16 v[84:87], a[248:251], a[104:107], v[84:87]
    buffer_load_dwordx4 a[0:3], v23, s[68:71], s26 offen offset:0 sc1
    v_mfma_f32_16x16x32_bf16 v[76:79], a[248:251], a[100:103], v[76:79]
    ds_read_b64_tr_b16 a[236:237], v30 offset:61440
    v_mfma_f32_16x16x32_bf16 v[76:79], a[252:255], a[116:119], v[76:79]
    ds_read_b64_tr_b16 a[238:239], v30 offset:61952
    v_mfma_f32_16x16x32_bf16 v[68:71], a[252:255], a[112:115], v[68:71]
    v_mfma_f32_16x16x32_bf16 v[68:71], a[248:251], a[96:99], v[68:71]
    s_waitcnt lgkmcnt(4)
    v_mfma_f32_16x16x32_bf16 v[96:99], a[224:227], a[96:99], v[96:99]
    buffer_load_dwordx4 a[4:7], v23, s[68:71], s26 offen offset:1024 sc1
    v_mfma_f32_16x16x32_bf16 v[96:99], a[228:231], a[112:115], v[96:99]
    ds_read_b64_tr_b16 a[240:241], v29 offset:0
    ds_read_b64_tr_b16 a[242:243], v29 offset:512
    v_mfma_f32_16x16x32_bf16 v[104:107], a[228:231], a[116:119], v[104:107]
    v_mfma_f32_16x16x32_bf16 v[104:107], a[224:227], a[100:103], v[104:107]
    buffer_load_dwordx4 a[8:11], v23, s[68:71], s26 offen offset:2048 sc1
    v_mfma_f32_16x16x32_bf16 v[112:115], a[224:227], a[104:107], v[112:115]
    ds_read_b64_tr_b16 a[244:245], v29 offset:4096
    v_mfma_f32_16x16x32_bf16 v[112:115], a[228:231], a[120:123], v[112:115]
    ds_read_b64_tr_b16 a[246:247], v29 offset:4608
    v_mfma_f32_16x16x32_bf16 v[120:123], a[228:231], a[124:127], v[120:123]
    v_mfma_f32_16x16x32_bf16 v[120:123], a[224:227], a[108:111], v[120:123]
    s_waitcnt lgkmcnt(4)
    v_mfma_f32_16x16x32_bf16 v[124:127], a[232:235], a[108:111], v[124:127]
    buffer_load_dwordx4 a[12:15], v23, s[68:71], s26 offen offset:3072 sc1
    s_barrier
    v_mfma_f32_16x16x32_bf16 v[124:127], a[236:239], a[124:127], v[124:127]
    s_add_u32 m0, s86, 49152
    ds_read_b64_tr_b16 a[248:249], v31 offset:0
    v_mfma_f32_16x16x32_bf16 v[116:119], a[236:239], a[120:123], v[116:119]
    s_add_u32 s52, s52, 28672
    s_addc_u32 s53, s53, 0
    v_mfma_f32_16x16x32_bf16 v[116:119], a[232:235], a[104:107], v[116:119]
    buffer_load_dwordx4 v19, s[52:55], s29 offen offset:0 lds
    v_mfma_f32_16x16x32_bf16 v[108:111], a[232:235], a[100:103], v[108:111]
    ds_read_b64_tr_b16 a[250:251], v31 offset:512
    ds_read_b64_tr_b16 a[252:253], v31 offset:4096
    v_mfma_f32_16x16x32_bf16 v[108:111], a[236:239], a[116:119], v[108:111]
    ds_read_b64_tr_b16 a[254:255], v31 offset:4608
    v_mfma_f32_16x16x32_bf16 v[100:103], a[236:239], a[112:115], v[100:103]
    v_mfma_f32_16x16x32_bf16 v[100:103], a[232:235], a[96:99], v[100:103]
    s_waitcnt lgkmcnt(4)
    v_mfma_f32_16x16x32_bf16 v[64:67], a[240:243], a[128:131], v[64:67]
    buffer_load_dwordx4 v20, s[52:55], s29 offen offset:1024 lds
    v_mfma_f32_16x16x32_bf16 v[64:67], a[244:247], a[144:147], v[64:67]
    ds_read_b64_tr_b16 a[224:225], v29 offset:8192
    ds_read_b64_tr_b16 a[226:227], v29 offset:8704
    v_mfma_f32_16x16x32_bf16 v[72:75], a[244:247], a[148:151], v[72:75]
    v_mfma_f32_16x16x32_bf16 v[72:75], a[240:243], a[132:135], v[72:75]
    buffer_load_dwordx4 v21, s[52:55], s29 offen offset:2048 lds
    v_mfma_f32_16x16x32_bf16 v[80:83], a[240:243], a[136:139], v[80:83]
    ds_read_b64_tr_b16 a[228:229], v29 offset:12288
    v_mfma_f32_16x16x32_bf16 v[80:83], a[244:247], a[152:155], v[80:83]
    ds_read_b64_tr_b16 a[230:231], v29 offset:12800
    v_mfma_f32_16x16x32_bf16 v[88:91], a[244:247], a[156:159], v[88:91]
    v_mfma_f32_16x16x32_bf16 v[88:91], a[240:243], a[140:143], v[88:91]
    s_waitcnt lgkmcnt(4)
    v_mfma_f32_16x16x32_bf16 v[92:95], a[248:251], a[140:143], v[92:95]
    buffer_load_dwordx4 v22, s[52:55], s29 offen offset:3072 lds
    v_mfma_f32_16x16x32_bf16 v[92:95], a[252:255], a[156:159], v[92:95]
    ds_read_b64_tr_b16 a[232:233], v31 offset:8192
    ds_read_b64_tr_b16 a[234:235], v31 offset:8704
    v_mfma_f32_16x16x32_bf16 v[84:87], a[252:255], a[152:155], v[84:87]
    v_mfma_f32_16x16x32_bf16 v[84:87], a[248:251], a[136:139], v[84:87]
    buffer_load_dwordx4 a[16:19], v23, s[68:71], s27 offen offset:0 sc1
    v_mfma_f32_16x16x32_bf16 v[76:79], a[248:251], a[132:135], v[76:79]
    ds_read_b64_tr_b16 a[236:237], v31 offset:12288
    s_load_dwordx8 s[12:19], s[36:37], s89 offset:0 glc
    v_mfma_f32_16x16x32_bf16 v[76:79], a[252:255], a[148:151], v[76:79]
    ds_read_b64_tr_b16 a[238:239], v31 offset:12800
    v_mfma_f32_16x16x32_bf16 v[68:71], a[252:255], a[144:147], v[68:71]
    v_mfma_f32_16x16x32_bf16 v[68:71], a[248:251], a[128:131], v[68:71]
    s_waitcnt lgkmcnt(4)
    v_mfma_f32_16x16x32_bf16 v[96:99], a[224:227], a[128:131], v[96:99]
    buffer_load_dwordx4 a[20:23], v23, s[68:71], s27 offen offset:1024 sc1
    v_mfma_f32_16x16x32_bf16 v[96:99], a[228:231], a[144:147], v[96:99]
    ds_read_b64_tr_b16 a[240:241], v29 offset:16384
    ds_read_b64_tr_b16 a[242:243], v29 offset:16896
    v_mfma_f32_16x16x32_bf16 v[104:107], a[228:231], a[148:151], v[104:107]
    v_mfma_f32_16x16x32_bf16 v[104:107], a[224:227], a[132:135], v[104:107]
    buffer_load_dwordx4 a[24:27], v23, s[68:71], s27 offen offset:2048 sc1
    v_mfma_f32_16x16x32_bf16 v[112:115], a[224:227], a[136:139], v[112:115]
    ds_read_b64_tr_b16 a[244:245], v29 offset:20480
    v_mfma_f32_16x16x32_bf16 v[112:115], a[228:231], a[152:155], v[112:115]
    ds_read_b64_tr_b16 a[246:247], v29 offset:20992
    v_mfma_f32_16x16x32_bf16 v[120:123], a[228:231], a[156:159], v[120:123]
    v_mfma_f32_16x16x32_bf16 v[120:123], a[224:227], a[140:143], v[120:123]
    s_waitcnt lgkmcnt(4)
    v_mfma_f32_16x16x32_bf16 v[124:127], a[232:235], a[140:143], v[124:127]
    buffer_load_dwordx4 a[28:31], v23, s[68:71], s27 offen offset:3072 sc1
    s_barrier
    v_mfma_f32_16x16x32_bf16 v[124:127], a[236:239], a[156:159], v[124:127]
    s_add_u32 m0, s86, 65536
    ds_read_b64_tr_b16 a[248:249], v31 offset:16384
    v_mfma_f32_16x16x32_bf16 v[116:119], a[236:239], a[152:155], v[116:119]
    ds_read_b64_tr_b16 a[250:251], v31 offset:16896
    v_mfma_f32_16x16x32_bf16 v[116:119], a[232:235], a[136:139], v[116:119]
    buffer_load_dwordx4 v19, s[52:55], s30 offen offset:0 lds
    v_mfma_f32_16x16x32_bf16 v[108:111], a[232:235], a[132:135], v[108:111]
    ds_read_b64_tr_b16 a[252:253], v31 offset:20480
    v_mfma_f32_16x16x32_bf16 v[108:111], a[236:239], a[148:151], v[108:111]
    ds_read_b64_tr_b16 a[254:255], v31 offset:20992
    buffer_load_dwordx4 v[2:5], v234, s[56:59], 0 offen offset:0 sc1
    buffer_load_dwordx4 v[6:9], v234, s[56:59], 0 offen offset:256 sc1
    v_mfma_f32_16x16x32_bf16 v[100:103], a[236:239], a[144:147], v[100:103]
    v_mfma_f32_16x16x32_bf16 v[100:103], a[232:235], a[128:131], v[100:103]
    s_waitcnt lgkmcnt(4)
    v_mfma_f32_16x16x32_bf16 v[64:67], a[240:243], a[160:163], v[64:67]
    buffer_load_dwordx4 v20, s[52:55], s30 offen offset:1024 lds
    v_mfma_f32_16x16x32_bf16 v[64:67], a[244:247], a[176:179], v[64:67]
    ds_read_b64_tr_b16 a[224:225], v29 offset:24576
    ds_read_b64_tr_b16 a[226:227], v29 offset:25088
    v_mfma_f32_16x16x32_bf16 v[72:75], a[244:247], a[180:183], v[72:75]
    v_mfma_f32_16x16x32_bf16 v[72:75], a[240:243], a[164:167], v[72:75]
    buffer_load_dwordx4 v21, s[52:55], s30 offen offset:2048 lds
    v_mfma_f32_16x16x32_bf16 v[80:83], a[240:243], a[168:171], v[80:83]
    ds_read_b64_tr_b16 a[228:229], v29 offset:28672
    v_mfma_f32_16x16x32_bf16 v[80:83], a[244:247], a[184:187], v[80:83]
    ds_read_b64_tr_b16 a[230:231], v29 offset:29184
    v_mfma_f32_16x16x32_bf16 v[88:91], a[244:247], a[188:191], v[88:91]
    v_mfma_f32_16x16x32_bf16 v[88:91], a[240:243], a[172:175], v[88:91]
    s_waitcnt lgkmcnt(4)
    v_mfma_f32_16x16x32_bf16 v[92:95], a[248:251], a[172:175], v[92:95]
    buffer_load_dwordx4 v22, s[52:55], s30 offen offset:3072 lds
    v_mfma_f32_16x16x32_bf16 v[92:95], a[252:255], a[188:191], v[92:95]
    ds_read_b64_tr_b16 a[232:233], v31 offset:24576
    ds_read_b64_tr_b16 a[234:235], v31 offset:25088
    v_mfma_f32_16x16x32_bf16 v[84:87], a[252:255], a[184:187], v[84:87]
    v_mfma_f32_16x16x32_bf16 v[84:87], a[248:251], a[168:171], v[84:87]
    buffer_load_dwordx4 a[32:35], v23, s[68:71], s28 offen offset:0 sc1
    v_mfma_f32_16x16x32_bf16 v[76:79], a[248:251], a[164:167], v[76:79]
    ds_read_b64_tr_b16 a[236:237], v31 offset:28672
    v_mfma_f32_16x16x32_bf16 v[76:79], a[252:255], a[180:183], v[76:79]
    ds_read_b64_tr_b16 a[238:239], v31 offset:29184
    v_mfma_f32_16x16x32_bf16 v[68:71], a[252:255], a[176:179], v[68:71]
    v_mfma_f32_16x16x32_bf16 v[68:71], a[248:251], a[160:163], v[68:71]
    s_waitcnt lgkmcnt(4)
    v_mfma_f32_16x16x32_bf16 v[96:99], a[224:227], a[160:163], v[96:99]
    buffer_load_dwordx4 a[36:39], v23, s[68:71], s28 offen offset:1024 sc1
    v_mfma_f32_16x16x32_bf16 v[96:99], a[228:231], a[176:179], v[96:99]
    ds_read_b64_tr_b16 a[240:241], v29 offset:32768
    ds_read_b64_tr_b16 a[242:243], v29 offset:33280
    v_mfma_f32_16x16x32_bf16 v[104:107], a[228:231], a[180:183], v[104:107]
    s_waitcnt lgkmcnt(0)
    s_xor_b64 s[12:13], s[12:13], s[38:39]
    v_mfma_f32_16x16x32_bf16 v[104:107], a[224:227], a[164:167], v[104:107]
    buffer_load_dwordx4 a[40:43], v23, s[68:71], s28 offen offset:2048 sc1
    v_mfma_f32_16x16x32_bf16 v[112:115], a[224:227], a[168:171], v[112:115]
    ds_read_b64_tr_b16 a[244:245], v29 offset:36864
    s_xor_b64 s[14:15], s[14:15], s[38:39]
    v_mfma_f32_16x16x32_bf16 v[112:115], a[228:231], a[184:187], v[112:115]
    ds_read_b64_tr_b16 a[246:247], v29 offset:37376
    s_xor_b64 s[16:17], s[16:17], s[38:39]
    v_mfma_f32_16x16x32_bf16 v[120:123], a[228:231], a[188:191], v[120:123]
    s_xor_b32 s18, s18, s38
    s_or_b64 s[12:13], s[12:13], s[14:15]
    v_mfma_f32_16x16x32_bf16 v[120:123], a[224:227], a[172:175], v[120:123]
    s_or_b32 s16, s16, s18
    v_mfma_f32_16x16x32_bf16 v[124:127], a[232:235], a[172:175], v[124:127]
    buffer_load_dwordx4 a[44:47], v23, s[68:71], s28 offen offset:3072 sc1
    s_barrier
    v_mfma_f32_16x16x32_bf16 v[124:127], a[236:239], a[188:191], v[124:127]
    ds_read_b64_tr_b16 a[248:249], v31 offset:32768
    ds_read_b64_tr_b16 a[250:251], v31 offset:33280
    s_or_b64 s[12:13], s[12:13], s[16:17]
    s_cbranch_scc1 L_slow_h0
L_back_h0:
    v_mfma_f32_16x16x32_bf16 v[116:119], a[236:239], a[184:187], v[116:119]
    buffer_load_dwordx4 a[48:51], v23, s[64:67], s22 offen offset:0 sc1
    v_mfma_f32_16x16x32_bf16 v[116:119], a[232:235], a[168:171], v[116:119]
    s_waitcnt vmcnt(8)
    v_xor_b32 v3, v37, v3
    v_mfma_f32_16x16x32_bf16 v[108:111], a[232:235], a[164:167], v[108:111]
    ds_read_b64_tr_b16 a[252:253], v31 offset:36864
    v_xor_b32 v5, v37, v5
    v_mfma_f32_16x16x32_bf16 v[108:111], a[236:239], a[180:183], v[108:111]
    buffer_load_dwordx4 a[52:55], v23, s[64:67], s22 offen offset:1024 sc1
    v_mfma_f32_16x16x32_bf16 v[100:103], a[236:239], a[176:179], v[100:103]
    ds_read_b64_tr_b16 a[254:255], v31 offset:37376
    v_cndmask_b32 v2, 0, v2, s[44:45]
    v_mfma_f32_16x16x32_bf16 v[100:103], a[232:235], a[160:163], v[100:103]
    v_or_b32 v3, v3, v5
    s_waitcnt lgkmcnt(4)
    v_mfma_f32_16x16x32_bf16 v[64:67], a[240:243], a[192:195], v[64:67]
    buffer_load_dwordx4 a[56:59], v23, s[64:67], s22 offen offset:2048 sc1
    v_mfma_f32_16x16x32_bf16 v[64:67], a[244:247], a[208:211], v[64:67]
    ds_read_b64_tr_b16 a[224:225], v29 offset:40960
    ds_read_b64_tr_b16 a[226:227], v29 offset:41472
    v_mfma_f32_16x16x32_bf16 v[72:75], a[244:247], a[212:215], v[72:75]
    v_cndmask_b32 v4, 0, v4, s[44:45]
    v_cndmask_b32 v3, 0, v3, s[44:45]
    v_mfma_f32_16x16x32_bf16 v[72:75], a[240:243], a[196:199], v[72:75]
    v_xor_b32 v7, v37, v7
    v_xor_b32 v9, v37, v9
    v_mfma_f32_16x16x32_bf16 v[80:83], a[240:243], a[200:203], v[80:83]
    buffer_load_dwordx4 a[60:63], v23, s[64:67], s22 offen offset:3072 sc1
    v_mfma_f32_16x16x32_bf16 v[80:83], a[244:247], a[216:219], v[80:83]
    ds_read_b64_tr_b16 a[228:229], v29 offset:45056
    ds_read_b64_tr_b16 a[230:231], v29 offset:45568
    v_mfma_f32_16x16x32_bf16 v[88:91], a[244:247], a[220:223], v[88:91]
    v_cndmask_b32 v6, 0, v6, s[46:47]
    v_or_b32 v7, v7, v9
    v_mfma_f32_16x16x32_bf16 v[88:91], a[240:243], a[204:207], v[88:91]
    v_cndmask_b32 v8, 0, v8, s[46:47]
    s_waitcnt lgkmcnt(4)
    v_mfma_f32_16x16x32_bf16 v[92:95], a[248:251], a[204:207], v[92:95]
    buffer_load_dwordx4 a[64:67], v23, s[64:67], s23 offen offset:0 sc1
    v_mfma_f32_16x16x32_bf16 v[92:95], a[252:255], a[220:223], v[92:95]
    ds_read_b64_tr_b16 a[232:233], v31 offset:40960
    ds_read_b64_tr_b16 a[234:235], v31 offset:41472
    v_mfma_f32_16x16x32_bf16 v[84:87], a[252:255], a[216:219], v[84:87]
    buffer_load_dwordx4 a[68:71], v23, s[64:67], s23 offen offset:1024 sc1
    v_mfma_f32_16x16x32_bf16 v[84:87], a[248:251], a[200:203], v[84:87]
    v_cndmask_b32 v7, 0, v7, s[46:47]
    v_or_b32 v3, v3, v7
    v_mfma_f32_16x16x32_bf16 v[76:79], a[248:251], a[196:199], v[76:79]
    ds_read_b64_tr_b16 a[236:237], v31 offset:45056
    v_cmp_ne_u32 vcc, 0, v3
    v_mfma_f32_16x16x32_bf16 v[76:79], a[252:255], a[212:215], v[76:79]
    buffer_load_dwordx4 a[72:75], v23, s[64:67], s23 offen offset:2048 sc1
    v_mfma_f32_16x16x32_bf16 v[68:71], a[252:255], a[208:211], v[68:71]
    ds_read_b64_tr_b16 a[238:239], v31 offset:45568
    v_mfma_f32_16x16x32_bf16 v[68:71], a[248:251], a[192:195], v[68:71]
    s_nop 0
    s_cbranch_vccnz L_slow_st
L_back_st:
    s_waitcnt lgkmcnt(4)
    v_mfma_f32_16x16x32_bf16 v[96:99], a[224:227], a[192:195], v[96:99]
    buffer_load_dwordx4 a[76:79], v23, s[64:67], s23 offen offset:3072 sc1
    v_mfma_f32_16x16x32_bf16 v[96:99], a[228:231], a[208:211], v[96:99]
    s_add_u32 m0, s86, 81920
    ds_read_b64_tr_b16 a[240:241], v32 offset:49152
    v_mfma_f32_16x16x32_bf16 v[104:107], a[228:231], a[212:215], v[104:107]
    ds_read_b64_tr_b16 a[242:243], v32 offset:51200
    v_fmac_f32 v6, v49, v2
    v_mfma_f32_16x16x32_bf16 v[104:107], a[224:227], a[196:199], v[104:107]
    buffer_load_dwordx4 v19, s[52:55], s31 offen offset:0 lds
    v_mfma_f32_16x16x32_bf16 v[112:115], a[224:227], a[200:203], v[112:115]
    ds_read_b64_tr_b16 a[244:245], v33 offset:49152
    v_add_u32 v32, 65536, v32
    v_mfma_f32_16x16x32_bf16 v[112:115], a[228:231], a[216:219], v[112:115]
    ds_read_b64_tr_b16 a[246:247], v33 offset:51200
    v_fmac_f32 v8, v49, v4
    v_mfma_f32_16x16x32_bf16 v[120:123], a[228:231], a[220:223], v[120:123]
    v_fma_f32 v6, -v50, v4, v6
    v_fmac_f32 v8, v50, v2
    v_mfma_f32_16x16x32_bf16 v[120:123], a[224:227], a[204:207], v[120:123]
    v_add_u32 v33, 65536, v33
    s_waitcnt lgkmcnt(4)
    v_mfma_f32_16x16x32_bf16 v[124:127], a[232:235], a[204:207], v[124:127]
    buffer_load_dwordx4 v20, s[52:55], s31 offen offset:1024 lds
    s_barrier
    v_mfma_f32_16x16x32_bf16 v[124:127], a[236:239], a[220:223], v[124:127]
    ds_read_b64_tr_b16 a[248:249], v34 offset:49152
    ds_read_b64_tr_b16 a[250:251], v34 offset:51200
    v_mfma_f32_16x16x32_bf16 v[116:119], a[236:239], a[216:219], v[116:119]
    buffer_load_dwordx4 v21, s[52:55], s31 offen offset:2048 lds
    v_mfma_f32_16x16x32_bf16 v[116:119], a[232:235], a[200:203], v[116:119]
    v_add_u32 v34, 65536, v34
    v_mov_b32 v2, v6
    v_mfma_f32_16x16x32_bf16 v[108:111], a[232:235], a[196:199], v[108:111]
    ds_read_b64_tr_b16 a[252:253], v35 offset:49152
    v_mov_b32 v3, v8
    v_mfma_f32_16x16x32_bf16 v[108:111], a[236:239], a[212:215], v[108:111]
    buffer_load_dwordx4 v22, s[52:55], s31 offen offset:3072 lds
    v_mfma_f32_16x16x32_bf16 v[100:103], a[236:239], a[208:211], v[100:103]
    ds_read_b64_tr_b16 a[254:255], v35 offset:51200
    v_mfma_f32_16x16x32_bf16 v[100:103], a[232:235], a[192:195], v[100:103]
    v_add_u32 v35, 65536, v35
    v_pk_mul_f32 v[64:65], v[64:65], v[14:15] op_sel_hi:[1,0]
    v_pk_mul_f32 v[66:67], v[66:67], v[14:15] op_sel_hi:[1,0]
    v_pk_mul_f32 v[68:69], v[68:69], v[14:15] op_sel_hi:[1,0]
    v_pk_mul_f32 v[70:71], v[70:71], v[14:15] op_sel_hi:[1,0]
    v_pk_mul_f32 v[64:65], v[64:65], v[96:97]
    v_pk_mul_f32 v[66:67], v[66:67], v[98:99]
    s_nop 0
    v_pk_mul_f32 v[68:69], v[68:69], v[100:101]
    v_pk_mul_f32 v[70:71], v[70:71], v[102:103]
    v_cvt_pk_bf16_f32 v96, v64, v65
    v_cvt_pk_bf16_f32 v97, v66, v67
    v_cvt_pk_bf16_f32 v98, v68, v69
    v_cvt_pk_bf16_f32 v99, v70, v71
    buffer_store_dwordx4 v[96:99], v23, s[56:59], s90 offen offset:0 sc1
    v_pk_mul_f32 v[72:73], v[72:73], v[14:15] op_sel:[0,1] op_sel_hi:[1,1]
    v_pk_mul_f32 v[74:75], v[74:75], v[14:15] op_sel:[0,1] op_sel_hi:[1,1]
    v_pk_mul_f32 v[76:77], v[76:77], v[14:15] op_sel:[0,1] op_sel_hi:[1,1]
    v_pk_mul_f32 v[78:79], v[78:79], v[14:15] op_sel:[0,1] op_sel_hi:[1,1]
    v_pk_mul_f32 v[72:73], v[72:73], v[104:105]
    v_pk_mul_f32 v[74:75], v[74:75], v[106:107]
    v_pk_mul_f32 v[76:77], v[76:77], v[108:109]
    v_pk_mul_f32 v[78:79], v[78:79], v[110:111]
    v_cvt_pk_bf16_f32 v104, v72, v73
    v_cvt_pk_bf16_f32 v105, v74, v75
    v_cvt_pk_bf16_f32 v106, v76, v77
    v_cvt_pk_bf16_f32 v107, v78, v79
    buffer_store_dwordx4 v[104:107], v23, s[56:59], s90 offen offset:1024 sc1
    v_pk_mul_f32 v[80:81], v[80:81], v[16:17] op_sel_hi:[1,0]
    v_pk_mul_f32 v[82:83], v[82:83], v[16:17] op_sel_hi:[1,0]
    v_pk_mul_f32 v[84:85], v[84:85], v[16:17] op_sel_hi:[1,0]
    v_pk_mul_f32 v[86:87], v[86:87], v[16:17] op_sel_hi:[1,0]
    v_pk_mul_f32 v[80:81], v[80:81], v[112:113]
    v_pk_mul_f32 v[82:83], v[82:83], v[114:115]
    v_pk_mul_f32 v[84:85], v[84:85], v[116:117]
    v_pk_mul_f32 v[86:87], v[86:87], v[118:119]
    v_cvt_pk_bf16_f32 v112, v80, v81
    v_cvt_pk_bf16_f32 v113, v82, v83
    v_cvt_pk_bf16_f32 v114, v84, v85
    v_cvt_pk_bf16_f32 v115, v86, v87
    buffer_store_dwordx4 v[112:115], v23, s[56:59], s90 offen offset:2048 sc1
    v_pk_mul_f32 v[88:89], v[88:89], v[16:17] op_sel:[0,1] op_sel_hi:[1,1]
    v_pk_mul_f32 v[90:91], v[90:91], v[16:17] op_sel:[0,1] op_sel_hi:[1,1]
    v_pk_mul_f32 v[92:93], v[92:93], v[16:17] op_sel:[0,1] op_sel_hi:[1,1]
    v_pk_mul_f32 v[94:95], v[94:95], v[16:17] op_sel:[0,1] op_sel_hi:[1,1]
    v_pk_mul_f32 v[88:89], v[88:89], v[120:121]
    v_pk_mul_f32 v[90:91], v[90:91], v[122:123]
    v_pk_mul_f32 v[92:93], v[92:93], v[124:125]
    v_pk_mul_f32 v[94:95], v[94:95], v[126:127]
    v_cvt_pk_bf16_f32 v120, v88, v89
    v_cvt_pk_bf16_f32 v121, v90, v91
    v_cvt_pk_bf16_f32 v122, v92, v93
    v_cvt_pk_bf16_f32 v123, v94, v95
    buffer_store_dwordx4 v[120:123], v23, s[56:59], s90 offen offset:3072 sc1
    s_waitcnt vmcnt(12) lgkmcnt(4)
    v_mfma_f32_16x16x32_bf16 v[64:67], a[240:243], a[48:51], 0
    v_permlane16_swap_b32 v6, v2
    v_mfma_f32_16x16x32_bf16 v[68:71], a[240:243], a[52:55], 0
    buffer_load_dwordx4 a[80:83], v23, s[64:67], s24 offen offset:0 sc1
    v_permlane16_swap_b32 v8, v3
    v_fmac_f32 v2, v51, v6
    v_fmac_f32 v3, v51, v8
    v_fma_f32 v2, -v52, v8, v2
    v_fmac_f32 v3, v52, v6
    v_mov_b32 v4, v2
    v_mov_b32 v5, v3
    s_nop 0
    v_permlane32_swap_b32 v2, v4
    v_permlane32_swap_b32 v3, v5
    v_fmac_f32 v4, v53, v2
    v_fmac_f32 v5, v53, v3
    v_fma_f32 v4, -v54, v3, v4
    v_mfma_f32_16x16x32_bf16 v[72:75], a[240:243], a[56:59], 0
    ds_read_b64_tr_b16 a[224:225], v32 offset:0
    ds_read_b64_tr_b16 a[226:227], v32 offset:2048
    v_fmac_f32 v5, v54, v2
    v_fmac_f32 v60, v57, v4
    v_fmac_f32 v61, v57, v5
    v_fma_f32 v60, -v58, v5, v60
    v_fmac_f32 v61, v58, v4
    ds_read_b128 v[2:5], v248 offset:0
    ds_read_b128 v[6:9], v248 offset:64
    ds_read_b128 v[48:51], v248 offset:128
    ds_read_b128 v[52:55], v248 offset:192
    v_fmac_f32 v59, v40, v60
    v_fmac_f32 v208, v40, v61
    v_fmac_f32 v59, v42, v61
    v_mfma_f32_16x16x32_bf16 v[76:79], a[240:243], a[60:63], 0
    buffer_load_dwordx4 a[84:87], v23, s[64:67], s24 offen offset:1024 sc1
    v_fmac_f32 v208, v41, v60
    v_fmac_f32 v192, v40, v59
    v_fmac_f32 v209, v40, v208
    v_fmac_f32 v192, v42, v208
    v_fmac_f32 v209, v41, v59
    v_fmac_f32 v193, v40, v192
    v_fmac_f32 v210, v40, v209
    v_fmac_f32 v193, v42, v209
    v_fmac_f32 v210, v41, v192
    v_fmac_f32 v194, v40, v193
    v_fmac_f32 v211, v40, v210
    v_fmac_f32 v194, v42, v210
    v_mfma_f32_16x16x32_bf16 v[92:95], a[244:247], a[60:63], 0
    ds_read_b64_tr_b16 a[228:229], v33 offset:0
    v_add_u32 v32, 4294836224, v32
    v_fmac_f32 v211, v41, v193
    v_fmac_f32 v195, v40, v194
    v_fmac_f32 v212, v40, v211
    v_fmac_f32 v195, v42, v211
    v_fmac_f32 v212, v41, v194
    v_fmac_f32 v196, v40, v195
    v_fmac_f32 v213, v40, v212
    v_fmac_f32 v196, v42, v212
    v_fmac_f32 v213, v41, v195
    v_fmac_f32 v197, v40, v196
    v_fmac_f32 v214, v40, v213
    v_fmac_f32 v197, v42, v213
    v_mfma_f32_16x16x32_bf16 v[88:91], a[244:247], a[56:59], 0
    buffer_load_dwordx4 a[88:91], v23, s[64:67], s24 offen offset:2048 sc1
    v_fmac_f32 v214, v41, v196
    v_fmac_f32 v198, v40, v197
    v_fmac_f32 v215, v40, v214
    v_fmac_f32 v198, v42, v214
    v_fmac_f32 v215, v41, v197
    v_fmac_f32 v199, v40, v198
    v_fmac_f32 v216, v40, v215
    v_fmac_f32 v199, v42, v215
    v_fmac_f32 v216, v41, v198
    v_fmac_f32 v200, v40, v199
    v_fmac_f32 v217, v40, v216
    v_fmac_f32 v200, v42, v216
    v_fmac_f32 v217, v41, v199
    v_mfma_f32_16x16x32_bf16 v[84:87], a[244:247], a[52:55], 0
    ds_read_b64_tr_b16 a[230:231], v33 offset:2048
    v_fmac_f32 v201, v40, v200
    v_fmac_f32 v218, v40, v217
    v_fmac_f32 v201, v42, v217
    v_fmac_f32 v218, v41, v200
    v_fmac_f32 v202, v40, v201
    v_fmac_f32 v219, v40, v218
    v_fmac_f32 v202, v42, v218
    v_fmac_f32 v219, v41, v201
    v_fmac_f32 v203, v40, v202
    v_fmac_f32 v220, v40, v219
    v_fmac_f32 v203, v42, v219
    v_fmac_f32 v220, v41, v202
    v_mfma_f32_16x16x32_bf16 v[80:83], a[244:247], a[48:51], 0
    v_add_u32 v33, 4294836224, v33
    v_fmac_f32 v204, v40, v203
    v_fmac_f32 v221, v40, v220
    v_fmac_f32 v204, v42, v220
    v_fmac_f32 v221, v41, v203
    v_fmac_f32 v205, v40, v204
    v_fmac_f32 v222, v40, v221
    v_fmac_f32 v205, v42, v221
    v_fmac_f32 v222, v41, v204
    v_fmac_f32 v206, v40, v205
    v_fmac_f32 v223, v40, v222
    v_fmac_f32 v206, v42, v222
    v_fmac_f32 v223, v41, v205
    s_waitcnt lgkmcnt(8)
    v_mfma_f32_16x16x32_bf16 v[96:99], a[248:251], a[48:51], 0
    buffer_load_dwordx4 a[92:95], v23, s[64:67], s24 offen offset:3072 sc1
    s_waitcnt lgkmcnt(2)
    v_mul_f32 v59, v2, v59
    v_mul_f32 v208, v2, v208
    v_mul_f32 v192, v3, v192
    v_mul_f32 v209, v3, v209
    v_cvt_pk_bf16_f32 v192, v59, v192
    v_cvt_pk_bf16_f32 v208, -v208, -v209
    v_mul_f32 v193, v4, v193
    v_mul_f32 v210, v4, v210
    v_mul_f32 v194, v5, v194
    v_mul_f32 v211, v5, v211
    v_cvt_pk_bf16_f32 v193, v193, v194
    v_mfma_f32_16x16x32_bf16 v[100:103], a[248:251], a[52:55], 0
    buffer_load_dwordx4 a[96:99], v23, s[64:67], s25 offen offset:0 sc1
    v_cvt_pk_bf16_f32 v209, -v210, -v211
    v_mul_f32 v195, v6, v195
    v_mul_f32 v212, v6, v212
    v_mul_f32 v196, v7, v196
    v_mul_f32 v213, v7, v213
    v_cvt_pk_bf16_f32 v194, v195, v196
    v_cvt_pk_bf16_f32 v210, -v212, -v213
    v_mul_f32 v197, v8, v197
    v_mul_f32 v214, v8, v214
    v_mul_f32 v198, v9, v198
    v_mul_f32 v215, v9, v215
    v_cvt_pk_bf16_f32 v195, v197, v198
    v_cvt_pk_bf16_f32 v211, -v214, -v215
    v_mfma_f32_16x16x32_bf16 v[104:107], a[248:251], a[56:59], 0
    ds_read_b64_tr_b16 a[232:233], v34 offset:0
    ds_read_b64_tr_b16 a[234:235], v34 offset:2048
    ds_write_b128 v236, v[192:195] offset:0
    ds_write_b128 v236, v[208:211] offset:2048
    v_mul_f32 v199, v48, v199
    v_mul_f32 v216, v48, v216
    v_mul_f32 v200, v49, v200
    v_mul_f32 v217, v49, v217
    v_cvt_pk_bf16_f32 v196, v199, v200
    v_cvt_pk_bf16_f32 v212, -v216, -v217
    v_mul_f32 v201, v50, v201
    v_mul_f32 v218, v50, v218
    v_mul_f32 v202, v51, v202
    v_mul_f32 v219, v51, v219
    v_mfma_f32_16x16x32_bf16 v[108:111], a[248:251], a[60:63], 0
L_page3:
    s_cmp_eq_u32 s0, 1
    s_cbranch_scc1 L_warm
    buffer_load_dwordx4 a[100:103], v23, s[64:67], s25 offen offset:1024 sc1
    v_cvt_pk_bf16_f32 v197, v201, v202
    v_cvt_pk_bf16_f32 v213, -v218, -v219
    v_mul_f32 v203, v52, v203
    v_mul_f32 v220, v52, v220
    v_mul_f32 v204, v53, v204
    v_mul_f32 v221, v53, v221
    v_cvt_pk_bf16_f32 v198, v203, v204
    v_cvt_pk_bf16_f32 v214, -v220, -v221
    v_mul_f32 v205, v54, v205
    v_mul_f32 v222, v54, v222
    v_mul_f32 v206, v55, v206
    v_mul_f32 v223, v55, v223
    v_mfma_f32_16x16x32_bf16 v[124:127], a[252:255], a[60:63], 0
    ds_read_b64_tr_b16 a[236:237], v35 offset:0
    v_add_u32 v34, 4294836224, v34
    v_cvt_pk_bf16_f32 v199, v205, v206
    v_cvt_pk_bf16_f32 v215, -v222, -v223
    ds_write_b128 v237, v[196:199] offset:0
    ds_write_b128 v237, v[212:215] offset:2048
    ds_read_b64_tr_b16 v[200:201], v238 offset:0
    ds_read_b64_tr_b16 v[202:203], v240 offset:512
    ds_read_b64_tr_b16 v[204:205], v238 offset:8
    ds_read_b64_tr_b16 v[206:207], v240 offset:520
    ds_read_b64_tr_b16 v[216:217], v239 offset:0
    ds_read_b64_tr_b16 v[218:219], v241 offset:512
    ds_read_b64_tr_b16 v[220:221], v239 offset:8
    ds_read_b64_tr_b16 v[222:223], v241 offset:520
    v_mfma_f32_16x16x32_bf16 v[120:123], a[252:255], a[56:59], 0
    buffer_load_dwordx4 a[104:107], v23, s[64:67], s25 offen offset:2048 sc1
    v_mfma_f32_16x16x32_bf16 v[116:119], a[252:255], a[52:55], 0
    ds_read_b64_tr_b16 a[238:239], v35 offset:2048
    s_waitcnt lgkmcnt(1)
    v_mfma_f32_16x16x32_bf16 v[112:115], a[252:255], a[48:51], 0
    v_add_u32 v35, 4294836224, v35
    buffer_store_dwordx4 v[200:203], v23, s[56:59], s91 offen offset:0 sc1
    buffer_store_dwordx4 v[204:207], v23, s[56:59], s91 offen offset:1024 sc1
    buffer_store_dwordx4 v[216:219], v23, s[56:59], s91 offen offset:2048 sc1
    buffer_store_dwordx4 v[220:223], v23, s[56:59], s91 offen offset:3072 sc1
    s_waitcnt vmcnt(19)
    v_mfma_f32_16x16x32_bf16 v[64:67], a[224:227], a[64:67], v[64:67]
    buffer_load_dwordx4 a[108:111], v23, s[64:67], s25 offen offset:3072 sc1
    v_mfma_f32_16x16x32_bf16 v[68:71], a[224:227], a[68:71], v[68:71]
    buffer_load_dwordx4 a[112:115], v23, s[64:67], s26 offen offset:0 sc1
    v_mfma_f32_16x16x32_bf16 v[72:75], a[224:227], a[72:75], v[72:75]
    ds_read_b64_tr_b16 a[240:241], v32 offset:0
    ds_read_b64_tr_b16 a[242:243], v32 offset:2048
    s_waitcnt vmcnt(13)
    s_atomic_swap s38, s[36:37], s88 offset:512
    v_mfma_f32_16x16x32_bf16 v[76:79], a[224:227], a[76:79], v[76:79]
    buffer_load_dwordx4 a[116:119], v23, s[64:67], s26 offen offset:1024 sc1
    v_mfma_f32_16x16x32_bf16 v[92:95], a[228:231], a[76:79], v[92:95]
    ds_read_b64_tr_b16 a[244:245], v33 offset:0
    v_mfma_f32_16x16x32_bf16 v[88:91], a[228:231], a[72:75], v[88:91]
    buffer_load_dwordx4 a[120:123], v23, s[64:67], s26 offen offset:2048 sc1
    v_mfma_f32_16x16x32_bf16 v[84:87], a[228:231], a[68:71], v[84:87]
    ds_read_b64_tr_b16 a[246:247], v33 offset:2048
    v_mfma_f32_16x16x32_bf16 v[80:83], a[228:231], a[64:67], v[80:83]
    s_add_u32 m0, s86, 98304
    s_waitcnt lgkmcnt(4)
    v_mfma_f32_16x16x32_bf16 v[96:99], a[232:235], a[64:67], v[96:99]
    buffer_load_dwordx4 a[124:127], v23, s[64:67], s26 offen offset:3072 sc1
    v_mfma_f32_16x16x32_bf16 v[100:103], a[232:235], a[68:71], v[100:103]
    buffer_load_dwordx4 v19, s[52:55], s32 offen offset:0 lds
    v_mfma_f32_16x16x32_bf16 v[104:107], a[232:235], a[72:75], v[104:107]
    ds_read_b64_tr_b16 a[248:249], v34 offset:0
    ds_read_b64_tr_b16 a[250:251], v34 offset:2048
    v_mfma_f32_16x16x32_bf16 v[108:111], a[232:235], a[76:79], v[108:111]
    buffer_load_dwordx4 v20, s[52:55], s32 offen offset:1024 lds
    v_mfma_f32_16x16x32_bf16 v[124:127], a[236:239], a[76:79], v[124:127]
    ds_read_b64_tr_b16 a[252:253], v35 offset:0
    v_mfma_f32_16x16x32_bf16 v[120:123], a[236:239], a[72:75], v[120:123]
    buffer_load_dwordx4 v21, s[52:55], s32 offen offset:2048 lds
    v_mfma_f32_16x16x32_bf16 v[116:119], a[236:239], a[68:71], v[116:119]
    ds_read_b64_tr_b16 a[254:255], v35 offset:2048
    v_mfma_f32_16x16x32_bf16 v[112:115], a[236:239], a[64:67], v[112:115]
    s_waitcnt vmcnt(15) lgkmcnt(4)
    v_mfma_f32_16x16x32_bf16 v[64:67], a[240:243], a[80:83], v[64:67]
    buffer_load_dwordx4 v22, s[52:55], s32 offen offset:3072 lds
    v_mfma_f32_16x16x32_bf16 v[68:71], a[240:243], a[84:87], v[68:71]
    s_add_u32 m0, s86, 114688
    ds_read_b64_tr_b16 a[224:225], v32 offset:16384
    v_mfma_f32_16x16x32_bf16 v[72:75], a[240:243], a[88:91], v[72:75]
    buffer_load_dwordx4 v19, s[52:55], s33 offen offset:0 lds
    v_mfma_f32_16x16x32_bf16 v[76:79], a[240:243], a[92:95], v[76:79]
    buffer_load_dwordx4 v20, s[52:55], s33 offen offset:1024 lds
    v_mfma_f32_16x16x32_bf16 v[92:95], a[244:247], a[92:95], v[92:95]
    ds_read_b64_tr_b16 a[226:227], v32 offset:18432
    ds_read_b64_tr_b16 a[228:229], v33 offset:16384
    s_waitcnt vmcnt(11)
    s_atomic_swap s38, s[36:37], s88 offset:576
    v_mfma_f32_16x16x32_bf16 v[88:91], a[244:247], a[88:91], v[88:91]
    buffer_load_dwordx4 v21, s[52:55], s33 offen offset:2048 lds
    v_mfma_f32_16x16x32_bf16 v[84:87], a[244:247], a[84:87], v[84:87]
    ds_read_b64_tr_b16 a[230:231], v33 offset:18432
    v_mfma_f32_16x16x32_bf16 v[80:83], a[244:247], a[80:83], v[80:83]
    s_waitcnt lgkmcnt(4)
    v_mfma_f32_16x16x32_bf16 v[96:99], a[248:251], a[80:83], v[96:99]
    buffer_load_dwordx4 v22, s[52:55], s33 offen offset:3072 lds
    v_mfma_f32_16x16x32_bf16 v[100:103], a[248:251], a[84:87], v[100:103]
    s_add_u32 m0, s86, 131072
    ds_read_b64_tr_b16 a[232:233], v34 offset:16384
    v_mfma_f32_16x16x32_bf16 v[104:107], a[248:251], a[88:91], v[104:107]
    buffer_load_dwordx4 v19, s[52:55], s34 offen offset:0 lds
    v_mfma_f32_16x16x32_bf16 v[108:111], a[248:251], a[92:95], v[108:111]
    buffer_load_dwordx4 v20, s[52:55], s34 offen offset:1024 lds
    v_mfma_f32_16x16x32_bf16 v[124:127], a[252:255], a[92:95], v[124:127]
    ds_read_b64_tr_b16 a[234:235], v34 offset:18432
    ds_read_b64_tr_b16 a[236:237], v35 offset:16384
    v_mfma_f32_16x16x32_bf16 v[120:123], a[252:255], a[88:91], v[120:123]
    buffer_load_dwordx4 v21, s[52:55], s34 offen offset:2048 lds
    v_mfma_f32_16x16x32_bf16 v[116:119], a[252:255], a[84:87], v[116:119]
    ds_read_b64_tr_b16 a[238:239], v35 offset:18432
    s_load_dwordx8 s[12:19], s[36:37], s89 offset:512 glc
    v_mfma_f32_16x16x32_bf16 v[112:115], a[252:255], a[80:83], v[112:115]
    s_waitcnt vmcnt(15) lgkmcnt(4)
    v_mfma_f32_16x16x32_bf16 v[64:67], a[224:227], a[96:99], v[64:67]
    buffer_load_dwordx4 v22, s[52:55], s34 offen offset:3072 lds
    v_mfma_f32_16x16x32_bf16 v[68:71], a[224:227], a[100:103], v[68:71]
    s_add_u32 m0, s86, 0
    ds_read_b64_tr_b16 a[240:241], v32 offset:32768
    v_mfma_f32_16x16x32_bf16 v[72:75], a[224:227], a[104:107], v[72:75]
    buffer_load_dwordx4 v19, s[52:55], s35 offen offset:0 lds
    v_mfma_f32_16x16x32_bf16 v[76:79], a[224:227], a[108:111], v[76:79]
    ds_read_b64_tr_b16 a[242:243], v32 offset:34816
    v_mfma_f32_16x16x32_bf16 v[92:95], a[228:231], a[108:111], v[92:95]
    ds_read_b64_tr_b16 a[244:245], v33 offset:32768
    v_mfma_f32_16x16x32_bf16 v[88:91], a[228:231], a[104:107], v[88:91]
    ds_read_b64_tr_b16 a[246:247], v33 offset:34816
    v_mfma_f32_16x16x32_bf16 v[84:87], a[228:231], a[100:103], v[84:87]
    buffer_load_dwordx4 v20, s[52:55], s35 offen offset:1024 lds
    v_mfma_f32_16x16x32_bf16 v[80:83], a[228:231], a[96:99], v[80:83]
    s_waitcnt lgkmcnt(4)
    v_mfma_f32_16x16x32_bf16 v[96:99], a[232:235], a[96:99], v[96:99]
    ds_read_b64_tr_b16 a[248:249], v34 offset:32768
    s_waitcnt lgkmcnt(0)
    v_mfma_f32_16x16x32_bf16 v[100:103], a[232:235], a[100:103], v[100:103]
    ds_read_b64_tr_b16 a[250:251], v34 offset:34816
    s_xor_b64 s[12:13], s[12:13], s[38:39]
    v_mfma_f32_16x16x32_bf16 v[104:107], a[232:235], a[104:107], v[104:107]
    buffer_load_dwordx4 v21, s[52:55], s35 offen offset:2048 lds
    v_mfma_f32_16x16x32_bf16 v[108:111], a[232:235], a[108:111], v[108:111]
    s_xor_b64 s[14:15], s[14:15], s[38:39]
    s_xor_b64 s[16:17], s[16:17], s[38:39]
    v_mfma_f32_16x16x32_bf16 v[124:127], a[236:239], a[108:111], v[124:127]
    ds_read_b64_tr_b16 a[252:253], v35 offset:32768
    s_xor_b32 s18, s18, s38
    v_mfma_f32_16x16x32_bf16 v[120:123], a[236:239], a[104:107], v[120:123]
    ds_read_b64_tr_b16 a[254:255], v35 offset:34816
    s_or_b64 s[12:13], s[12:13], s[14:15]
    v_mfma_f32_16x16x32_bf16 v[116:119], a[236:239], a[100:103], v[116:119]
    buffer_load_dwordx4 v22, s[52:55], s35 offen offset:3072 lds
    s_or_b32 s16, s16, s18
    v_mfma_f32_16x16x32_bf16 v[112:115], a[236:239], a[96:99], v[112:115]
    s_add_u32 s64, s64, 114688
    s_addc_u32 s65, s65, 0
    s_or_b64 s[12:13], s[12:13], s[16:17]
    s_cbranch_scc1 L_slow_h1
L_back_h1:
    s_waitcnt vmcnt(16)
    v_mfma_f32_16x16x32_bf16 v[64:67], a[240:243], a[112:115], v[64:67]
    buffer_load_dwordx4 a[128:131], v23, s[64:67], s22 offen offset:0 sc1
    v_mfma_f32_16x16x32_bf16 v[68:71], a[240:243], a[116:119], v[68:71]
    ds_read_b64_tr_b16 a[224:225], v32 offset:49152
    ds_read_b64_tr_b16 a[226:227], v32 offset:51200
    v_mfma_f32_16x16x32_bf16 v[72:75], a[240:243], a[120:123], v[72:75]
    buffer_load_dwordx4 a[132:135], v23, s[64:67], s22 offen offset:1024 sc1
    v_mfma_f32_16x16x32_bf16 v[76:79], a[240:243], a[124:127], v[76:79]
    buffer_load_dwordx4 a[136:139], v23, s[64:67], s22 offen offset:2048 sc1
    v_mfma_f32_16x16x32_bf16 v[92:95], a[244:247], a[124:127], v[92:95]
    buffer_load_dwordx4 a[140:143], v23, s[64:67], s22 offen offset:3072 sc1
    v_mfma_f32_16x16x32_bf16 v[88:91], a[244:247], a[120:123], v[88:91]
    ds_read_b64_tr_b16 a[228:229], v33 offset:49152
    ds_read_b64_tr_b16 a[230:231], v33 offset:51200
    v_mfma_f32_16x16x32_bf16 v[84:87], a[244:247], a[116:119], v[84:87]
    buffer_load_dwordx4 a[144:147], v23, s[64:67], s23 offen offset:0 sc1
    v_mfma_f32_16x16x32_bf16 v[80:83], a[244:247], a[112:115], v[80:83]
    v_add_u32 v32, 65536, v32
    s_waitcnt lgkmcnt(4)
    v_mfma_f32_16x16x32_bf16 v[96:99], a[248:251], a[112:115], v[96:99]
    buffer_load_dwordx4 a[148:151], v23, s[64:67], s23 offen offset:1024 sc1
    v_mfma_f32_16x16x32_bf16 v[100:103], a[248:251], a[116:119], v[100:103]
    buffer_load_dwordx4 a[152:155], v23, s[64:67], s23 offen offset:2048 sc1
    v_mfma_f32_16x16x32_bf16 v[104:107], a[248:251], a[120:123], v[104:107]
    buffer_load_dwordx4 a[156:159], v23, s[64:67], s23 offen offset:3072 sc1
    v_mfma_f32_16x16x32_bf16 v[108:111], a[248:251], a[124:127], v[108:111]
    buffer_load_dwordx4 a[160:163], v23, s[64:67], s24 offen offset:0 sc1
    ds_read_b64_tr_b16 a[232:233], v34 offset:49152
    v_mfma_f32_16x16x32_bf16 v[124:127], a[252:255], a[124:127], v[124:127]
    buffer_load_dwordx4 a[164:167], v23, s[64:67], s24 offen offset:1024 sc1
    ds_read_b64_tr_b16 a[234:235], v34 offset:51200
    v_mfma_f32_16x16x32_bf16 v[120:123], a[252:255], a[120:123], v[120:123]
    ds_read_b64_tr_b16 a[236:237], v35 offset:49152
    ds_read_b64_tr_b16 a[238:239], v35 offset:51200
    v_mfma_f32_16x16x32_bf16 v[116:119], a[252:255], a[116:119], v[116:119]
    buffer_load_dwordx4 a[168:171], v23, s[64:67], s24 offen offset:2048 sc1
    v_mfma_f32_16x16x32_bf16 v[112:115], a[252:255], a[112:115], v[112:115]
    v_add_u32 v33, 65536, v33
    s_waitcnt vmcnt(7) lgkmcnt(4)
    v_mfma_f32_16x16x32_bf16 v[64:67], a[224:227], a[128:131], v[64:67]
    buffer_load_dwordx4 a[172:175], v23, s[64:67], s24 offen offset:3072 sc1
    v_mfma_f32_16x16x32_bf16 v[68:71], a[224:227], a[132:135], v[68:71]
    ds_read_b64_tr_b16 a[240:241], v32 offset:0
    ds_read_b64_tr_b16 a[242:243], v32 offset:2048
    v_mfma_f32_16x16x32_bf16 v[72:75], a[224:227], a[136:139], v[72:75]
    buffer_load_dwordx4 a[176:179], v23, s[64:67], s25 offen offset:0 sc1
    v_mfma_f32_16x16x32_bf16 v[76:79], a[224:227], a[140:143], v[76:79]
    v_add_u32 v34, 65536, v34
    v_add_u32 v35, 65536, v35
    v_mfma_f32_16x16x32_bf16 v[92:95], a[228:231], a[140:143], v[92:95]
    ds_read_b64_tr_b16 a[244:245], v33 offset:0
    s_load_dwordx8 s[12:19], s[36:37], s89 offset:576 glc
    v_mfma_f32_16x16x32_bf16 v[88:91], a[228:231], a[136:139], v[88:91]
    ds_read_b64_tr_b16 a[246:247], v33 offset:2048
    v_mfma_f32_16x16x32_bf16 v[84:87], a[228:231], a[132:135], v[84:87]
    buffer_load_dwordx4 a[180:183], v23, s[64:67], s25 offen offset:1024 sc1
    v_mfma_f32_16x16x32_bf16 v[80:83], a[228:231], a[128:131], v[80:83]
    s_waitcnt lgkmcnt(4)
    v_mfma_f32_16x16x32_bf16 v[96:99], a[232:235], a[128:131], v[96:99]
    ds_read_b64_tr_b16 a[248:249], v34 offset:0
    v_mfma_f32_16x16x32_bf16 v[100:103], a[232:235], a[132:135], v[100:103]
    ds_read_b64_tr_b16 a[250:251], v34 offset:2048
    v_mfma_f32_16x16x32_bf16 v[104:107], a[232:235], a[136:139], v[104:107]
    buffer_load_dwordx4 a[184:187], v23, s[64:67], s25 offen offset:2048 sc1
    v_mfma_f32_16x16x32_bf16 v[108:111], a[232:235], a[140:143], v[108:111]
    v_mfma_f32_16x16x32_bf16 v[124:127], a[236:239], a[140:143], v[124:127]
    ds_read_b64_tr_b16 a[252:253], v35 offset:0
    v_mfma_f32_16x16x32_bf16 v[120:123], a[236:239], a[136:139], v[120:123]
    ds_read_b64_tr_b16 a[254:255], v35 offset:2048
    v_mfma_f32_16x16x32_bf16 v[116:119], a[236:239], a[132:135], v[116:119]
    buffer_load_dwordx4 a[188:191], v23, s[64:67], s25 offen offset:3072 sc1
    v_mfma_f32_16x16x32_bf16 v[112:115], a[236:239], a[128:131], v[112:115]
    s_waitcnt vmcnt(8) lgkmcnt(4)
    v_mfma_f32_16x16x32_bf16 v[64:67], a[240:243], a[144:147], v[64:67]
    v_mfma_f32_16x16x32_bf16 v[68:71], a[240:243], a[148:151], v[68:71]
    ds_read_b64_tr_b16 a[224:225], v32 offset:16384
    ds_read_b64_tr_b16 a[226:227], v32 offset:18432
    v_mfma_f32_16x16x32_bf16 v[72:75], a[240:243], a[152:155], v[72:75]
    buffer_load_dwordx4 a[192:195], v23, s[64:67], s26 offen offset:0 sc1
    v_mfma_f32_16x16x32_bf16 v[76:79], a[240:243], a[156:159], v[76:79]
    v_mfma_f32_16x16x32_bf16 v[92:95], a[244:247], a[156:159], v[92:95]
    ds_read_b64_tr_b16 a[228:229], v33 offset:16384
    v_mfma_f32_16x16x32_bf16 v[88:91], a[244:247], a[152:155], v[88:91]
    ds_read_b64_tr_b16 a[230:231], v33 offset:18432
    v_mfma_f32_16x16x32_bf16 v[84:87], a[244:247], a[148:151], v[84:87]
    buffer_load_dwordx4 a[196:199], v23, s[64:67], s26 offen offset:1024 sc1
    v_mfma_f32_16x16x32_bf16 v[80:83], a[244:247], a[144:147], v[80:83]
    s_waitcnt lgkmcnt(4)
    v_mfma_f32_16x16x32_bf16 v[96:99], a[248:251], a[144:147], v[96:99]
    ds_read_b64_tr_b16 a[232:233], v34 offset:16384
    v_mfma_f32_16x16x32_bf16 v[100:103], a[248:251], a[148:151], v[100:103]
    ds_read_b64_tr_b16 a[234:235], v34 offset:18432
    v_mfma_f32_16x16x32_bf16 v[104:107], a[248:251], a[152:155], v[104:107]
    buffer_load_dwordx4 a[200:203], v23, s[64:67], s26 offen offset:2048 sc1
    v_mfma_f32_16x16x32_bf16 v[108:111], a[248:251], a[156:159], v[108:111]
    v_mfma_f32_16x16x32_bf16 v[124:127], a[252:255], a[156:159], v[124:127]
    ds_read_b64_tr_b16 a[236:237], v35 offset:16384
    v_mfma_f32_16x16x32_bf16 v[120:123], a[252:255], a[152:155], v[120:123]
    ds_read_b64_tr_b16 a[238:239], v35 offset:18432
    v_mfma_f32_16x16x32_bf16 v[116:119], a[252:255], a[148:151], v[116:119]
    buffer_load_dwordx4 a[204:207], v23, s[64:67], s26 offen offset:3072 sc1
    v_mfma_f32_16x16x32_bf16 v[112:115], a[252:255], a[144:147], v[112:115]
    s_waitcnt vmcnt(8) lgkmcnt(4)
    v_mfma_f32_16x16x32_bf16 v[64:67], a[224:227], a[160:163], v[64:67]
    v_mfma_f32_16x16x32_bf16 v[68:71], a[224:227], a[164:167], v[68:71]
    ds_read_b64_tr_b16 a[240:241], v32 offset:32768
    ds_read_b64_tr_b16 a[242:243], v32 offset:34816
    v_mfma_f32_16x16x32_bf16 v[72:75], a[224:227], a[168:171], v[72:75]
    buffer_load_dwordx4 a[208:211], v23, s[64:67], s27 offen offset:0 sc1
    v_mfma_f32_16x16x32_bf16 v[76:79], a[224:227], a[172:175], v[76:79]
    v_mfma_f32_16x16x32_bf16 v[92:95], a[228:231], a[172:175], v[92:95]
    ds_read_b64_tr_b16 a[244:245], v33 offset:32768
    v_mfma_f32_16x16x32_bf16 v[88:91], a[228:231], a[168:171], v[88:91]
    ds_read_b64_tr_b16 a[246:247], v33 offset:34816
    v_mfma_f32_16x16x32_bf16 v[84:87], a[228:231], a[164:167], v[84:87]
    buffer_load_dwordx4 a[212:215], v23, s[64:67], s27 offen offset:1024 sc1
    v_mfma_f32_16x16x32_bf16 v[80:83], a[228:231], a[160:163], v[80:83]
    s_waitcnt lgkmcnt(4)
    v_mfma_f32_16x16x32_bf16 v[96:99], a[232:235], a[160:163], v[96:99]
    ds_read_b64_tr_b16 a[248:249], v34 offset:32768
    v_mfma_f32_16x16x32_bf16 v[100:103], a[232:235], a[164:167], v[100:103]
    ds_read_b64_tr_b16 a[250:251], v34 offset:34816
    v_mfma_f32_16x16x32_bf16 v[104:107], a[232:235], a[168:171], v[104:107]
    buffer_load_dwordx4 a[216:219], v23, s[64:67], s27 offen offset:2048 sc1
    v_mfma_f32_16x16x32_bf16 v[108:111], a[232:235], a[172:175], v[108:111]
    v_mfma_f32_16x16x32_bf16 v[124:127], a[236:239], a[172:175], v[124:127]
    ds_read_b64_tr_b16 a[252:253], v35 offset:32768
    v_mfma_f32_16x16x32_bf16 v[120:123], a[236:239], a[168:171], v[120:123]
    ds_read_b64_tr_b16 a[254:255], v35 offset:34816
    v_mfma_f32_16x16x32_bf16 v[116:119], a[236:239], a[164:167], v[116:119]
    buffer_load_dwordx4 a[220:223], v23, s[64:67], s27 offen offset:3072 sc1
    v_mfma_f32_16x16x32_bf16 v[112:115], a[236:239], a[160:163], v[112:115]
    s_waitcnt vmcnt(8) lgkmcnt(4)
    v_mfma_f32_16x16x32_bf16 v[64:67], a[240:243], a[176:179], v[64:67]
    v_mfma_f32_16x16x32_bf16 v[68:71], a[240:243], a[180:183], v[68:71]
    ds_read_b64_tr_b16 a[224:225], v32 offset:49152
    ds_read_b64_tr_b16 a[226:227], v32 offset:51200
    v_mfma_f32_16x16x32_bf16 v[72:75], a[240:243], a[184:187], v[72:75]
    buffer_load_dwordx4 a[48:51], v23, s[64:67], s28 offen offset:0 sc1
    v_mfma_f32_16x16x32_bf16 v[76:79], a[240:243], a[188:191], v[76:79]
    s_waitcnt lgkmcnt(0)
    s_xor_b64 s[12:13], s[12:13], s[38:39]
    v_mfma_f32_16x16x32_bf16 v[92:95], a[244:247], a[188:191], v[92:95]
    ds_read_b64_tr_b16 a[228:229], v33 offset:49152
    v_add_u32 v32, 65536, v32
    v_mfma_f32_16x16x32_bf16 v[88:91], a[244:247], a[184:187], v[88:91]
    ds_read_b64_tr_b16 a[230:231], v33 offset:51200
    s_xor_b64 s[14:15], s[14:15], s[38:39]
    v_mfma_f32_16x16x32_bf16 v[84:87], a[244:247], a[180:183], v[84:87]
    buffer_load_dwordx4 a[52:55], v23, s[64:67], s28 offen offset:1024 sc1
    s_xor_b64 s[16:17], s[16:17], s[38:39]
    v_mfma_f32_16x16x32_bf16 v[80:83], a[244:247], a[176:179], v[80:83]
    s_xor_b32 s18, s18, s38
    s_or_b64 s[12:13], s[12:13], s[14:15]
    v_mfma_f32_16x16x32_bf16 v[96:99], a[248:251], a[176:179], v[96:99]
    ds_read_b64_tr_b16 a[232:233], v34 offset:49152
    s_or_b32 s16, s16, s18
    v_mfma_f32_16x16x32_bf16 v[100:103], a[248:251], a[180:183], v[100:103]
    ds_read_b64_tr_b16 a[234:235], v34 offset:51200
    s_or_b64 s[12:13], s[12:13], s[16:17]
    s_cbranch_scc1 L_slow_h2
L_back_h2:
    v_mfma_f32_16x16x32_bf16 v[104:107], a[248:251], a[184:187], v[104:107]
    buffer_load_dwordx4 a[56:59], v23, s[64:67], s28 offen offset:2048 sc1
    v_mfma_f32_16x16x32_bf16 v[108:111], a[248:251], a[188:191], v[108:111]
    v_add_u32 v33, 65536, v33
    v_add_u32 v34, 65536, v34
    v_mfma_f32_16x16x32_bf16 v[124:127], a[252:255], a[188:191], v[124:127]
    ds_read_b64_tr_b16 a[236:237], v35 offset:49152
    v_mfma_f32_16x16x32_bf16 v[120:123], a[252:255], a[184:187], v[120:123]
    ds_read_b64_tr_b16 a[238:239], v35 offset:51200
    v_mfma_f32_16x16x32_bf16 v[116:119], a[252:255], a[180:183], v[116:119]
    buffer_load_dwordx4 a[60:63], v23, s[64:67], s28 offen offset:3072 sc1
    v_mfma_f32_16x16x32_bf16 v[112:115], a[252:255], a[176:179], v[112:115]
    s_add_u32 s64, s64, 114688
    s_addc_u32 s65, s65, 0
    s_waitcnt vmcnt(8) lgkmcnt(4)
    v_mfma_f32_16x16x32_bf16 v[64:67], a[224:227], a[192:195], v[64:67]
    v_add_u32 v35, 65536, v35
    v_mfma_f32_16x16x32_bf16 v[68:71], a[224:227], a[196:199], v[68:71]
    ds_read_b64_tr_b16 a[240:241], v32 offset:0
    ds_read_b64_tr_b16 a[242:243], v32 offset:2048
    v_mfma_f32_16x16x32_bf16 v[72:75], a[224:227], a[200:203], v[72:75]
    buffer_load_dwordx4 a[64:67], v23, s[64:67], s22 offen offset:0 sc1
    v_mfma_f32_16x16x32_bf16 v[76:79], a[224:227], a[204:207], v[76:79]
    v_add_u32 v32, 4294836224, v32
    v_mfma_f32_16x16x32_bf16 v[92:95], a[228:231], a[204:207], v[92:95]
    ds_read_b64_tr_b16 a[244:245], v33 offset:0
    v_mfma_f32_16x16x32_bf16 v[88:91], a[228:231], a[200:203], v[88:91]
    ds_read_b64_tr_b16 a[246:247], v33 offset:2048
    v_mfma_f32_16x16x32_bf16 v[84:87], a[228:231], a[196:199], v[84:87]
    buffer_load_dwordx4 a[68:71], v23, s[64:67], s23 offen offset:0 sc1
    v_mfma_f32_16x16x32_bf16 v[80:83], a[228:231], a[192:195], v[80:83]
    v_add_u32 v33, 4294836224, v33
    s_waitcnt lgkmcnt(4)
    v_mfma_f32_16x16x32_bf16 v[96:99], a[232:235], a[192:195], v[96:99]
    ds_read_b64_tr_b16 a[248:249], v34 offset:0
    v_mfma_f32_16x16x32_bf16 v[100:103], a[232:235], a[196:199], v[100:103]
    ds_read_b64_tr_b16 a[250:251], v34 offset:2048
    v_mfma_f32_16x16x32_bf16 v[104:107], a[232:235], a[200:203], v[104:107]
    buffer_load_dwordx4 a[72:75], v23, s[64:67], s24 offen offset:0 sc1
    v_mfma_f32_16x16x32_bf16 v[108:111], a[232:235], a[204:207], v[108:111]
    v_add_u32 v34, 4294836224, v34
    v_mfma_f32_16x16x32_bf16 v[124:127], a[236:239], a[204:207], v[124:127]
    ds_read_b64_tr_b16 a[252:253], v35 offset:0
    v_mfma_f32_16x16x32_bf16 v[120:123], a[236:239], a[200:203], v[120:123]
    ds_read_b64_tr_b16 a[254:255], v35 offset:2048
    v_mfma_f32_16x16x32_bf16 v[116:119], a[236:239], a[196:199], v[116:119]
    buffer_load_dwordx4 a[76:79], v23, s[64:67], s25 offen offset:0 sc1
    v_mfma_f32_16x16x32_bf16 v[112:115], a[236:239], a[192:195], v[112:115]
    v_add_u32 v35, 4294836224, v35
    s_waitcnt vmcnt(8) lgkmcnt(4)
    v_mfma_f32_16x16x32_bf16 v[64:67], a[240:243], a[208:211], v[64:67]
    v_mfma_f32_16x16x32_bf16 v[68:71], a[240:243], a[212:215], v[68:71]
    ds_read_b64_tr_b16 a[224:225], v32 offset:0
    ds_read_b64_tr_b16 a[226:227], v32 offset:2048
    v_mfma_f32_16x16x32_bf16 v[72:75], a[240:243], a[216:219], v[72:75]
    buffer_load_dwordx4 a[80:83], v23, s[64:67], s26 offen offset:0 sc1
    v_mfma_f32_16x16x32_bf16 v[76:79], a[240:243], a[220:223], v[76:79]
    v_mfma_f32_16x16x32_bf16 v[92:95], a[244:247], a[220:223], v[92:95]
    ds_read_b64_tr_b16 a[228:229], v33 offset:0
    v_mfma_f32_16x16x32_bf16 v[88:91], a[244:247], a[216:219], v[88:91]
    ds_read_b64_tr_b16 a[230:231], v33 offset:2048
    v_mfma_f32_16x16x32_bf16 v[84:87], a[244:247], a[212:215], v[84:87]
    buffer_load_dwordx4 a[84:87], v23, s[64:67], s27 offen offset:0 sc1
    v_mfma_f32_16x16x32_bf16 v[80:83], a[244:247], a[208:211], v[80:83]
    s_waitcnt lgkmcnt(4)
    v_mfma_f32_16x16x32_bf16 v[96:99], a[248:251], a[208:211], v[96:99]
    ds_read_b64_tr_b16 a[232:233], v34 offset:0
    v_mfma_f32_16x16x32_bf16 v[100:103], a[248:251], a[212:215], v[100:103]
    ds_read_b64_tr_b16 a[234:235], v34 offset:2048
    v_mfma_f32_16x16x32_bf16 v[104:107], a[248:251], a[216:219], v[104:107]
    buffer_load_dwordx4 a[88:91], v23, s[64:67], s28 offen offset:0 sc1
    v_mfma_f32_16x16x32_bf16 v[108:111], a[248:251], a[220:223], v[108:111]
    v_mfma_f32_16x16x32_bf16 v[124:127], a[252:255], a[220:223], v[124:127]
    ds_read_b64_tr_b16 a[236:237], v35 offset:0
    v_mfma_f32_16x16x32_bf16 v[120:123], a[252:255], a[216:219], v[120:123]
    ds_read_b64_tr_b16 a[238:239], v35 offset:2048
    v_mfma_f32_16x16x32_bf16 v[116:119], a[252:255], a[212:215], v[116:119]
    buffer_load_dwordx4 a[92:95], v23, s[64:67], s22 offen offset:1024 sc1
    v_mfma_f32_16x16x32_bf16 v[112:115], a[252:255], a[208:211], v[112:115]
    s_waitcnt vmcnt(8) lgkmcnt(4)
    v_mfma_f32_16x16x32_bf16 v[64:67], a[224:227], a[48:51], v[64:67]
    v_mfma_f32_16x16x32_bf16 v[68:71], a[224:227], a[52:55], v[68:71]
    v_mfma_f32_16x16x32_bf16 v[72:75], a[224:227], a[56:59], v[72:75]
    buffer_load_dwordx4 a[96:99], v23, s[64:67], s23 offen offset:1024 sc1
    v_mfma_f32_16x16x32_bf16 v[76:79], a[224:227], a[60:63], v[76:79]
    v_mfma_f32_16x16x32_bf16 v[92:95], a[228:231], a[60:63], v[92:95]
    v_mfma_f32_16x16x32_bf16 v[88:91], a[228:231], a[56:59], v[88:91]
    v_mfma_f32_16x16x32_bf16 v[84:87], a[228:231], a[52:55], v[84:87]
    buffer_load_dwordx4 a[100:103], v23, s[64:67], s24 offen offset:1024 sc1
    v_mfma_f32_16x16x32_bf16 v[80:83], a[228:231], a[48:51], v[80:83]
    s_waitcnt lgkmcnt(0)
    v_mfma_f32_16x16x32_bf16 v[96:99], a[232:235], a[48:51], v[96:99]
    v_mfma_f32_16x16x32_bf16 v[100:103], a[232:235], a[52:55], v[100:103]
    v_mfma_f32_16x16x32_bf16 v[104:107], a[232:235], a[56:59], v[104:107]
    buffer_load_dwordx4 a[104:107], v23, s[64:67], s25 offen offset:1024 sc1
    v_mfma_f32_16x16x32_bf16 v[108:111], a[232:235], a[60:63], v[108:111]
    s_load_dword s12, s[36:37], s89 offset:608 glc
    v_mfma_f32_16x16x32_bf16 v[124:127], a[236:239], a[60:63], v[124:127]
    v_mfma_f32_16x16x32_bf16 v[120:123], a[236:239], a[56:59], v[120:123]
    v_mfma_f32_16x16x32_bf16 v[116:119], a[236:239], a[52:55], v[116:119]
    buffer_load_dwordx4 a[108:111], v23, s[64:67], s26 offen offset:1024 sc1
    v_mfma_f32_16x16x32_bf16 v[112:115], a[236:239], a[48:51], v[112:115]
    s_waitcnt vmcnt(10)
    v_mfma_f32_16x16x32_bf16 v[64:67], v[128:131], a[64:67], v[64:67]
    v_mfma_f32_16x16x32_bf16 v[80:83], v[132:135], a[64:67], v[80:83]
    v_mfma_f32_16x16x32_bf16 v[96:99], v[136:139], a[64:67], v[96:99]
    buffer_load_dwordx4 a[112:115], v23, s[64:67], s27 offen offset:1024 sc1
    v_mfma_f32_16x16x32_bf16 v[112:115], v[140:143], a[64:67], v[112:115]
    v_mfma_f32_16x16x32_bf16 v[64:67], v[144:147], a[68:71], v[64:67]
    v_mfma_f32_16x16x32_bf16 v[80:83], v[148:151], a[68:71], v[80:83]
    v_mfma_f32_16x16x32_bf16 v[96:99], v[152:155], a[68:71], v[96:99]
    buffer_load_dwordx4 a[116:119], v23, s[64:67], s28 offen offset:1024 sc1
    v_mfma_f32_16x16x32_bf16 v[112:115], v[156:159], a[68:71], v[112:115]
    s_waitcnt vmcnt(10)
    v_mfma_f32_16x16x32_bf16 v[64:67], v[160:163], a[72:75], v[64:67]
    v_mfma_f32_16x16x32_bf16 v[80:83], v[164:167], a[72:75], v[80:83]
    v_mfma_f32_16x16x32_bf16 v[96:99], v[168:171], a[72:75], v[96:99]
    buffer_load_dwordx4 a[120:123], v23, s[64:67], s22 offen offset:2048 sc1
    v_mfma_f32_16x16x32_bf16 v[112:115], v[172:175], a[72:75], v[112:115]
    v_mfma_f32_16x16x32_bf16 v[64:67], v[176:179], a[76:79], v[64:67]
    v_mfma_f32_16x16x32_bf16 v[80:83], v[180:183], a[76:79], v[80:83]
    v_mfma_f32_16x16x32_bf16 v[96:99], v[184:187], a[76:79], v[96:99]
    buffer_load_dwordx4 a[124:127], v23, s[64:67], s23 offen offset:2048 sc1
    v_mfma_f32_16x16x32_bf16 v[112:115], v[188:191], a[76:79], v[112:115]
    s_waitcnt vmcnt(10)
    v_mfma_f32_16x16x32_bf16 v[64:67], a[0:3], a[80:83], v[64:67]
    v_mfma_f32_16x16x32_bf16 v[80:83], a[4:7], a[80:83], v[80:83]
    v_mfma_f32_16x16x32_bf16 v[96:99], a[8:11], a[80:83], v[96:99]
    buffer_load_dwordx4 a[128:131], v23, s[64:67], s24 offen offset:2048 sc1
    v_mfma_f32_16x16x32_bf16 v[112:115], a[12:15], a[80:83], v[112:115]
    v_mfma_f32_16x16x32_bf16 v[64:67], a[16:19], a[84:87], v[64:67]
    v_mfma_f32_16x16x32_bf16 v[80:83], a[20:23], a[84:87], v[80:83]
    v_mfma_f32_16x16x32_bf16 v[96:99], a[24:27], a[84:87], v[96:99]
    buffer_load_dwordx4 a[132:135], v23, s[64:67], s25 offen offset:2048 sc1
    v_mfma_f32_16x16x32_bf16 v[112:115], a[28:31], a[84:87], v[112:115]
    s_waitcnt vmcnt(10)
    v_mfma_f32_16x16x32_bf16 v[64:67], a[32:35], a[88:91], v[64:67]
    v_mfma_f32_16x16x32_bf16 v[80:83], a[36:39], a[88:91], v[80:83]
    v_mfma_f32_16x16x32_bf16 v[96:99], a[40:43], a[88:91], v[96:99]
    buffer_load_dwordx4 a[136:139], v23, s[64:67], s26 offen offset:2048 sc1
    v_mfma_f32_16x16x32_bf16 v[112:115], a[44:47], a[88:91], v[112:115]
    v_mfma_f32_16x16x32_bf16 v[68:71], v[128:131], a[92:95], v[68:71]
    s_waitcnt lgkmcnt(0)
    v_mfma_f32_16x16x32_bf16 v[84:87], v[132:135], a[92:95], v[84:87]
    s_cmp_lg_u32 s12, s38
    s_cbranch_scc1 L_slow_p
L_back_p:
    v_mfma_f32_16x16x32_bf16 v[100:103], v[136:139], a[92:95], v[100:103]
    buffer_load_dwordx4 a[140:143], v23, s[64:67], s27 offen offset:2048 sc1
    v_mfma_f32_16x16x32_bf16 v[116:119], v[140:143], a[92:95], v[116:119]
    s_waitcnt vmcnt(10)
    v_mfma_f32_16x16x32_bf16 v[68:71], v[144:147], a[96:99], v[68:71]
    ds_write_b128 v249, v[64:67] offset:0
    v_mfma_f32_16x16x32_bf16 v[84:87], v[148:151], a[96:99], v[84:87]
    buffer_load_dwordx4 v[224:227], v253, s[56:59], 0 offen offset:0 sc1
    v_mfma_f32_16x16x32_bf16 v[100:103], v[152:155], a[96:99], v[100:103]
    ds_write_b128 v250, v[80:83] offset:0
    ds_write_b128 v249, v[96:99] offset:128
    v_mfma_f32_16x16x32_bf16 v[116:119], v[156:159], a[96:99], v[116:119]
    ds_write_b128 v250, v[112:115] offset:128
    v_mfma_f32_16x16x32_bf16 v[68:71], v[160:163], a[100:103], v[68:71]
    buffer_load_dwordx4 v[228:231], v253, s[56:59], 0 offen offset:1024 sc1
    v_mfma_f32_16x16x32_bf16 v[84:87], v[164:167], a[100:103], v[84:87]
    v_mfma_f32_16x16x32_bf16 v[100:103], v[168:171], a[100:103], v[100:103]
    buffer_load_dwordx4 a[144:147], v23, s[64:67], s28 offen offset:2048 sc1
    v_mfma_f32_16x16x32_bf16 v[116:119], v[172:175], a[100:103], v[116:119]
    s_waitcnt vmcnt(11)
    v_mfma_f32_16x16x32_bf16 v[68:71], v[176:179], a[104:107], v[68:71]
    v_mfma_f32_16x16x32_bf16 v[84:87], v[180:183], a[104:107], v[84:87]
    buffer_load_dwordx4 a[148:151], v23, s[64:67], s22 offen offset:3072 sc1
    v_mfma_f32_16x16x32_bf16 v[100:103], v[184:187], a[104:107], v[100:103]
    s_waitcnt lgkmcnt(0)
    s_barrier
    v_mfma_f32_16x16x32_bf16 v[116:119], v[188:191], a[104:107], v[116:119]
    ds_read_b128 v[64:67], v251 offset:0
    ds_read_b128 v[80:83], v251 offset:4096
    v_mfma_f32_16x16x32_bf16 v[68:71], a[0:3], a[108:111], v[68:71]
    buffer_load_dwordx4 a[152:155], v23, s[64:67], s23 offen offset:3072 sc1
    ds_read_b128 v[96:99], v251 offset:8192
    ds_read_b128 v[112:115], v251 offset:12288
    v_mfma_f32_16x16x32_bf16 v[84:87], a[4:7], a[108:111], v[84:87]
    v_mfma_f32_16x16x32_bf16 v[100:103], a[8:11], a[108:111], v[100:103]
    buffer_load_dwordx4 a[156:159], v23, s[64:67], s24 offen offset:3072 sc1
    v_mfma_f32_16x16x32_bf16 v[116:119], a[12:15], a[108:111], v[116:119]
    s_waitcnt vmcnt(12)
    v_mfma_f32_16x16x32_bf16 v[68:71], a[16:19], a[112:115], v[68:71]
    v_mfma_f32_16x16x32_bf16 v[84:87], a[20:23], a[112:115], v[84:87]
    v_mfma_f32_16x16x32_bf16 v[100:103], a[24:27], a[112:115], v[100:103]
    buffer_load_dwordx4 a[160:163], v23, s[64:67], s25 offen offset:3072 sc1
    v_mfma_f32_16x16x32_bf16 v[116:119], a[28:31], a[112:115], v[116:119]
    s_waitcnt lgkmcnt(0)
    v_add_f32 v208, v64, v112
    v_mfma_f32_16x16x32_bf16 v[68:71], a[32:35], a[116:119], v[68:71]
    v_add_f32 v209, v65, v113
    v_add_f32 v210, v66, v114
    v_mfma_f32_16x16x32_bf16 v[84:87], a[36:39], a[116:119], v[84:87]
    v_add_f32 v211, v67, v115
    v_add_f32 v80, v80, v96
    v_mfma_f32_16x16x32_bf16 v[100:103], a[40:43], a[116:119], v[100:103]
    buffer_load_dwordx4 a[164:167], v23, s[64:67], s26 offen offset:3072 sc1
    v_mfma_f32_16x16x32_bf16 v[116:119], a[44:47], a[116:119], v[116:119]
    v_add_f32 v81, v81, v97
    s_waitcnt vmcnt(12)
    v_mfma_f32_16x16x32_bf16 v[72:75], v[128:131], a[120:123], v[72:75]
    v_add_f32 v82, v82, v98
    v_add_f32 v83, v83, v99
    v_mfma_f32_16x16x32_bf16 v[88:91], v[132:135], a[120:123], v[88:91]
    v_add_f32 v208, v208, v80
    v_add_f32 v209, v209, v81
    v_mfma_f32_16x16x32_bf16 v[104:107], v[136:139], a[120:123], v[104:107]
    buffer_load_dwordx4 a[168:171], v23, s[64:67], s27 offen offset:3072 sc1
    v_mfma_f32_16x16x32_bf16 v[120:123], v[140:143], a[120:123], v[120:123]
    v_add_f32 v210, v210, v82
    v_add_f32 v211, v211, v83
    v_mfma_f32_16x16x32_bf16 v[72:75], v[144:147], a[124:127], v[72:75]
    ds_write_b128 v249, v[68:71] offset:16384
    v_mfma_f32_16x16x32_bf16 v[88:91], v[148:151], a[124:127], v[88:91]
    ds_write_b128 v250, v[84:87] offset:16384
    v_mfma_f32_16x16x32_bf16 v[104:107], v[152:155], a[124:127], v[104:107]
    buffer_load_dwordx4 a[172:175], v23, s[64:67], s28 offen offset:3072 sc1
    v_mfma_f32_16x16x32_bf16 v[120:123], v[156:159], a[124:127], v[120:123]
    ds_write_b128 v249, v[100:103] offset:16512
    s_waitcnt vmcnt(12)
    v_mfma_f32_16x16x32_bf16 v[72:75], v[160:163], a[128:131], v[72:75]
    ds_write_b128 v250, v[116:119] offset:16512
    s_waitcnt vmcnt(8)
    v_mfma_f32_16x16x32_bf16 v[88:91], v[164:167], a[128:131], v[88:91]
    v_lshlrev_b32 v2, 16, v224
    v_and_b32 v3, 0xffff0000, v224
    v_mfma_f32_16x16x32_bf16 v[104:107], v[168:171], a[128:131], v[104:107]
    v_lshlrev_b32 v4, 16, v225
    v_and_b32 v5, 0xffff0000, v225
    v_mfma_f32_16x16x32_bf16 v[120:123], v[172:175], a[128:131], v[120:123]
L_page4:
    s_cmp_eq_u32 s0, 1
    s_cbranch_scc1 L_warm
    v_add_f32 v208, v208, v2
    v_add_f32 v209, v209, v3
    v_mfma_f32_16x16x32_bf16 v[72:75], v[176:179], a[132:135], v[72:75]
    v_add_f32 v210, v210, v4
    v_add_f32 v211, v211, v5
    v_mfma_f32_16x16x32_bf16 v[88:91], v[180:183], a[132:135], v[88:91]
    buffer_store_dwordx4 v[208:211], v242, s[60:63], 0 offen sc1
    v_mfma_f32_16x16x32_bf16 v[104:107], v[184:187], a[132:135], v[104:107]
    v_lshlrev_b32 v212, 16, v226
    v_and_b32 v213, 0xffff0000, v226
    v_mfma_f32_16x16x32_bf16 v[120:123], v[188:191], a[132:135], v[120:123]
    v_lshlrev_b32 v214, 16, v227
    v_and_b32 v215, 0xffff0000, v227
    s_waitcnt lgkmcnt(0)
    s_barrier
    ds_read_b128 v[68:71], v251 offset:16384
    v_mfma_f32_16x16x32_bf16 v[72:75], a[0:3], a[136:139], v[72:75]
    ds_read_b128 v[84:87], v251 offset:20480
    ds_read_b128 v[100:103], v251 offset:24576
    ds_read_b128 v[116:119], v251 offset:28672
    v_mfma_f32_16x16x32_bf16 v[88:91], a[4:7], a[136:139], v[88:91]
    v_mfma_f32_16x16x32_bf16 v[104:107], a[8:11], a[136:139], v[104:107]
    v_lshlrev_b32 v216, 16, v228
    v_and_b32 v217, 0xffff0000, v228
    v_mfma_f32_16x16x32_bf16 v[120:123], a[12:15], a[136:139], v[120:123]
    v_lshlrev_b32 v218, 16, v229
    v_and_b32 v219, 0xffff0000, v229
    v_mfma_f32_16x16x32_bf16 v[72:75], a[16:19], a[140:143], v[72:75]
    v_mfma_f32_16x16x32_bf16 v[88:91], a[20:23], a[140:143], v[88:91]
    v_mfma_f32_16x16x32_bf16 v[104:107], a[24:27], a[140:143], v[104:107]
    s_waitcnt lgkmcnt(0)
    v_add_f32 v212, v212, v68
    v_mfma_f32_16x16x32_bf16 v[120:123], a[28:31], a[140:143], v[120:123]
    v_add_f32 v213, v213, v69
    s_waitcnt vmcnt(7)
    v_mfma_f32_16x16x32_bf16 v[72:75], a[32:35], a[144:147], v[72:75]
    v_add_f32 v214, v214, v70
    v_lshlrev_b32 v220, 16, v230
    v_mfma_f32_16x16x32_bf16 v[88:91], a[36:39], a[144:147], v[88:91]
    v_and_b32 v221, 0xffff0000, v230
    v_lshlrev_b32 v222, 16, v231
    v_mfma_f32_16x16x32_bf16 v[104:107], a[40:43], a[144:147], v[104:107]
    v_and_b32 v223, 0xffff0000, v231
    v_add_f32 v215, v215, v71
    v_mfma_f32_16x16x32_bf16 v[120:123], a[44:47], a[144:147], v[120:123]
    v_add_f32 v84, v84, v100
    v_add_f32 v85, v85, v101
    v_mfma_f32_16x16x32_bf16 v[76:79], v[128:131], a[148:151], v[76:79]
    v_add_f32 v86, v86, v102
    v_add_f32 v87, v87, v103
    v_mfma_f32_16x16x32_bf16 v[92:95], v[132:135], a[148:151], v[92:95]
    v_add_f32 v212, v212, v116
    v_add_f32 v213, v213, v117
    v_mfma_f32_16x16x32_bf16 v[108:111], v[136:139], a[148:151], v[108:111]
    v_add_f32 v214, v214, v118
    v_add_f32 v215, v215, v119
    v_mfma_f32_16x16x32_bf16 v[124:127], v[140:143], a[148:151], v[124:127]
    v_add_f32 v212, v212, v84
    v_add_f32 v213, v213, v85
    s_waitcnt vmcnt(5)
    v_mfma_f32_16x16x32_bf16 v[76:79], v[144:147], a[152:155], v[76:79]
    v_add_f32 v214, v214, v86
    v_add_f32 v215, v215, v87
    buffer_store_dwordx4 v[212:215], v242, s[60:63], s79 offen sc1
    v_mfma_f32_16x16x32_bf16 v[92:95], v[148:151], a[152:155], v[92:95]
    ds_write_b128 v249, v[72:75] offset:32768
    ds_write_b128 v250, v[88:91] offset:32768
    v_mfma_f32_16x16x32_bf16 v[108:111], v[152:155], a[152:155], v[108:111]
    v_mfma_f32_16x16x32_bf16 v[124:127], v[156:159], a[152:155], v[124:127]
    ds_write_b128 v249, v[104:107] offset:32896
    v_mfma_f32_16x16x32_bf16 v[76:79], v[160:163], a[156:159], v[76:79]
    ds_write_b128 v250, v[120:123] offset:32896
    v_mfma_f32_16x16x32_bf16 v[92:95], v[164:167], a[156:159], v[92:95]
    v_mfma_f32_16x16x32_bf16 v[108:111], v[168:171], a[156:159], v[108:111]
    v_mfma_f32_16x16x32_bf16 v[124:127], v[172:175], a[156:159], v[124:127]
    s_waitcnt vmcnt(4)
    v_mfma_f32_16x16x32_bf16 v[76:79], v[176:179], a[160:163], v[76:79]
    v_mfma_f32_16x16x32_bf16 v[92:95], v[180:183], a[160:163], v[92:95]
    v_mfma_f32_16x16x32_bf16 v[108:111], v[184:187], a[160:163], v[108:111]
    s_waitcnt lgkmcnt(0)
    s_barrier
    v_mfma_f32_16x16x32_bf16 v[124:127], v[188:191], a[160:163], v[124:127]
    ds_read_b128 v[72:75], v251 offset:32768
    ds_read_b128 v[88:91], v251 offset:36864
    v_mfma_f32_16x16x32_bf16 v[76:79], a[0:3], a[164:167], v[76:79]
    ds_read_b128 v[104:107], v251 offset:40960
    ds_read_b128 v[120:123], v251 offset:45056
    v_mfma_f32_16x16x32_bf16 v[92:95], a[4:7], a[164:167], v[92:95]
    v_mfma_f32_16x16x32_bf16 v[108:111], a[8:11], a[164:167], v[108:111]
    v_mfma_f32_16x16x32_bf16 v[124:127], a[12:15], a[164:167], v[124:127]
    s_waitcnt vmcnt(2)
    v_mfma_f32_16x16x32_bf16 v[76:79], a[16:19], a[168:171], v[76:79]
    s_waitcnt lgkmcnt(0)
    v_add_f32 v216, v216, v72
    v_mfma_f32_16x16x32_bf16 v[92:95], a[20:23], a[168:171], v[92:95]
    v_add_f32 v217, v217, v73
    v_add_f32 v218, v218, v74
    v_mfma_f32_16x16x32_bf16 v[108:111], a[24:27], a[168:171], v[108:111]
    v_add_f32 v219, v219, v75
    v_add_f32 v88, v88, v104
    v_mfma_f32_16x16x32_bf16 v[124:127], a[28:31], a[168:171], v[124:127]
    v_add_f32 v89, v89, v105
    v_add_f32 v90, v90, v106
    v_mfma_f32_16x16x32_bf16 v[76:79], a[32:35], a[172:175], v[76:79]
    v_add_f32 v91, v91, v107
    v_add_f32 v216, v216, v120
    v_mfma_f32_16x16x32_bf16 v[92:95], a[36:39], a[172:175], v[92:95]
    v_add_f32 v217, v217, v121
    v_add_f32 v218, v218, v122
    v_mfma_f32_16x16x32_bf16 v[108:111], a[40:43], a[172:175], v[108:111]
    v_add_f32 v219, v219, v123
    v_add_f32 v216, v216, v88
    v_mfma_f32_16x16x32_bf16 v[124:127], a[44:47], a[172:175], v[124:127]
    v_add_f32 v217, v217, v89
    v_add_f32 v218, v218, v90
    v_add_f32 v219, v219, v91
    buffer_store_dwordx4 v[216:219], v242, s[60:63], s80 offen sc1
    ds_write_b128 v249, v[76:79] offset:49152
    ds_write_b128 v250, v[92:95] offset:49152
    ds_write_b128 v249, v[108:111] offset:49280
    s_nop 0
    ds_write_b128 v250, v[124:127] offset:49280
    s_waitcnt lgkmcnt(0)
    s_barrier
    ds_read_b128 v[76:79], v251 offset:49152
    ds_read_b128 v[92:95], v251 offset:53248
    ds_read_b128 v[108:111], v251 offset:57344
    ds_read_b128 v[124:127], v251 offset:61440
    s_waitcnt lgkmcnt(0)
    v_pk_add_f32 v[220:221], v[220:221], v[76:77]
    v_pk_add_f32 v[222:223], v[222:223], v[78:79]
    v_pk_add_f32 v[92:93], v[92:93], v[108:109]
    v_pk_add_f32 v[94:95], v[94:95], v[110:111]
    v_pk_add_f32 v[220:221], v[220:221], v[124:125]
    v_pk_add_f32 v[222:223], v[222:223], v[126:127]
    v_pk_add_f32 v[220:221], v[220:221], v[92:93]
    v_pk_add_f32 v[222:223], v[222:223], v[94:95]
    buffer_store_dwordx4 v[220:223], v242, s[60:63], s81 offen nt
    s_endpgm
L_slow_c:
    s_mov_b32 s95, 1048576
L_spin_c:
    buffer_load_dword v7, v245, s[56:59], 0 offen sc1
    s_sub_u32 s95, s95, 1
    s_waitcnt vmcnt(0)
    s_cbranch_scc1 L_back_c
    v_xor_b32 v7, v37, v7
    v_cmp_ne_u32 vcc, 0, v7
    s_nop 1
    s_cbranch_vccnz L_spin_c
    s_branch L_back_c
L_slow_st:
    s_mov_b32 s95, 1048576
L_spin_st:
    buffer_load_dwordx4 v[2:5], v234, s[56:59], 0 offen offset:0 sc1
    buffer_load_dwordx4 v[6:9], v234, s[56:59], 0 offen offset:256 sc1
    s_sub_u32 s95, s95, 1
    s_waitcnt vmcnt(0)
    s_cbranch_scc1 L_back_st
    v_xor_b32 v3, v37, v3
    v_xor_b32 v5, v37, v5
    v_cndmask_b32 v2, 0, v2, s[44:45]
    v_or_b32 v3, v3, v5
    v_cndmask_b32 v4, 0, v4, s[44:45]
    v_cndmask_b32 v3, 0, v3, s[44:45]
    v_xor_b32 v7, v37, v7
    v_xor_b32 v9, v37, v9
    v_cndmask_b32 v6, 0, v6, s[46:47]
    v_or_b32 v7, v7, v9
    v_cndmask_b32 v8, 0, v8, s[46:47]
    v_cndmask_b32 v7, 0, v7, s[46:47]
    v_or_b32 v3, v3, v7
    v_cmp_ne_u32 vcc, 0, v3
    s_nop 1
    s_cbranch_vccnz L_spin_st
    s_branch L_back_st
L_slow_h0:
    s_mov_b32 s95, 1048576
L_spin_h0:
    s_load_dwordx8 s[12:19], s[36:37], s89 offset:0 glc
    s_sub_u32 s95, s95, 1
    s_waitcnt lgkmcnt(0)
    s_cbranch_scc1 L_back_h0
    s_xor_b64 s[12:13], s[12:13], s[38:39]
    s_xor_b64 s[14:15], s[14:15], s[38:39]
    s_xor_b64 s[16:17], s[16:17], s[38:39]
    s_xor_b32 s18, s18, s38
    s_or_b64 s[12:13], s[12:13], s[14:15]
    s_or_b32 s16, s16, s18
    s_or_b64 s[12:13], s[12:13], s[16:17]
    s_cbranch_scc1 L_spin_h0
    s_branch L_back_h0
L_slow_h2:
    s_mov_b32 s95, 1048576
L_spin_h2:
    s_load_dwordx8 s[12:19], s[36:37], s89 offset:576 glc
    s_sub_u32 s95, s95, 1
    s_waitcnt lgkmcnt(0)
    s_cbranch_scc1 L_back_h2
    s_xor_b64 s[12:13], s[12:13], s[38:39]
    s_xor_b64 s[14:15], s[14:15], s[38:39]
    s_xor_b64 s[16:17], s[16:17], s[38:39]
    s_xor_b32 s18, s18, s38
    s_or_b64 s[12:13], s[12:13], s[14:15]
    s_or_b32 s16, s16, s18
    s_or_b64 s[12:13], s[12:13], s[16:17]
    s_cbranch_scc1 L_spin_h2
    s_branch L_back_h2
L_slow_h1:
    s_mov_b32 s95, 1048576
L_spin_h1:
    s_load_dwordx8 s[12:19], s[36:37], s89 offset:512 glc
    s_sub_u32 s95, s95, 1
    s_waitcnt lgkmcnt(0)
    s_cbranch_scc1 L_back_h1
    s_xor_b64 s[12:13], s[12:13], s[38:39]
    s_xor_b64 s[14:15], s[14:15], s[38:39]
    s_xor_b64 s[16:17], s[16:17], s[38:39]
    s_xor_b32 s18, s18, s38
    s_or_b64 s[12:13], s[12:13], s[14:15]
    s_or_b32 s16, s16, s18
    s_or_b64 s[12:13], s[12:13], s[16:17]
    s_cbranch_scc1 L_spin_h1
    s_branch L_back_h1
L_slow_p:
    s_mov_b32 s95, 1048576
L_spin_p:
    s_load_dword s12, s[36:37], s89 offset:608 glc
    s_sub_u32 s95, s95, 1
    s_waitcnt lgkmcnt(0)
    s_cbranch_scc1 L_back_p
    s_cmp_lg_u32 s12, s38
    s_cbranch_scc1 L_spin_p
    s_branch L_back_p
L_spare:
    s_sub_u32 s66, s2, 224
    v_lshlrev_b32 v23, 4, v1
    s_and_b32 s77, s66, 7
    s_and_b32 s68, s66, 1
    s_lshr_b32 s69, s77, 1
    s_lshl2_add_u32 s68, s68, s69
    s_lshl2_add_u32 s68, s68, s73
    s_lshl2_add_u32 s70, s68, s3
    s_lshl4_add_u32 s71, s68, s3
    s_mul_i32 s71, s71, 3584
    v_cmp_gt_u32 vcc, 56, v1
    v_bfrev_b32 v3, 1
    v_mov_b32 v4, 0
    v_cndmask_b32 v6, v3, v23, vcc
    v_min_u32 v5, 55, v1
    v_lshlrev_b32 v5, 4, v5
    s_mov_b32 s59, 0x20000
    s_mov_b32 s58, 268435456
    s_waitcnt lgkmcnt(0)
    s_mov_b64 s[56:57], s[36:37]
    s_mov_b64 s[40:41], s[4:5]
    global_load_dword v37, v4, s[36:37] sc1
    global_load_dwordx4 v[60:63], v5, s[30:31]
    global_load_dwordx4 v[56:59], v5, s[20:21]
    buffer_load_dwordx4 v[64:67], v6, s[40:43], s71 offen offset:0
    buffer_load_dwordx4 v[68:71], v6, s[40:43], s71 offen offset:896
    buffer_load_dwordx4 v[72:75], v6, s[40:43], s71 offen offset:1792
    buffer_load_dwordx4 v[76:79], v6, s[40:43], s71 offen offset:2688
    s_add_u32 s71, s71, 14336
    buffer_load_dwordx4 v[80:83], v6, s[40:43], s71 offen offset:0
    buffer_load_dwordx4 v[84:87], v6, s[40:43], s71 offen offset:896
    buffer_load_dwordx4 v[88:91], v6, s[40:43], s71 offen offset:1792
    buffer_load_dwordx4 v[92:95], v6, s[40:43], s71 offen offset:2688
    s_add_u32 s71, s71, 14336
    buffer_load_dwordx4 v[96:99], v6, s[40:43], s71 offen offset:0
    buffer_load_dwordx4 v[100:103], v6, s[40:43], s71 offen offset:896
    buffer_load_dwordx4 v[104:107], v6, s[40:43], s71 offen offset:1792
    buffer_load_dwordx4 v[108:111], v6, s[40:43], s71 offen offset:2688
    s_add_u32 s71, s71, 14336
    buffer_load_dwordx4 v[112:115], v6, s[40:43], s71 offen offset:0
    buffer_load_dwordx4 v[116:119], v6, s[40:43], s71 offen offset:896
    buffer_load_dwordx4 v[120:123], v6, s[40:43], s71 offen offset:1792
    buffer_load_dwordx4 v[124:127], v6, s[40:43], s71 offen offset:2688
    v_lshlrev_b32 v2, 4, v0
    s_lshl_b32 s67, s66, 12
    buffer_load_dwordx4 v[252:255], v2, s[56:59], s67 offen
    s_min_u32 s67, s66, 27
    s_and_b32 s69, s3, 1
    s_lshl1_add_u32 s69, s67, s69
    s_mul_i32 s69, s69, 7168
    s_mul_i32 s75, s3, 7168
    s_cmp_ge_u32 s3, 2
    s_cselect_b64 s[44:45], s[16:17], s[14:15]
    s_mov_b32 s46, 401408
    s_mov_b32 s47, 0x20000
    s_mul_i32 s76, s3, 8320
    s_add_u32 m0, s76, 16384
    s_nop 0
    buffer_load_dwordx4 v6, s[44:47], s69 offen offset:0 lds
    s_add_u32 m0, s76, 16528
    s_nop 0
    buffer_load_dwordx4 v6, s[44:47], s69 offen offset:896 lds
    s_add_u32 m0, s76, 16672
    s_nop 0
    buffer_load_dwordx4 v6, s[44:47], s69 offen offset:1792 lds
    s_add_u32 m0, s76, 16816
    s_nop 0
    buffer_load_dwordx4 v6, s[44:47], s69 offen offset:2688 lds
    s_add_u32 s69, s69, 3584
    s_add_u32 m0, s76, 20544
    s_nop 0
    buffer_load_dwordx4 v6, s[44:47], s69 offen offset:0 lds
    s_add_u32 m0, s76, 20688
    s_nop 0
    buffer_load_dwordx4 v6, s[44:47], s69 offen offset:896 lds
    s_add_u32 m0, s76, 20832
    s_nop 0
    buffer_load_dwordx4 v6, s[44:47], s69 offen offset:1792 lds
    s_add_u32 m0, s76, 20976
    s_nop 0
    buffer_load_dwordx4 v6, s[44:47], s69 offen offset:2688 lds
    s_mov_b64 s[52:53], s[28:29]
    s_mov_b32 s54, 1605632
    s_mov_b32 s55, 0x20000
    s_mul_i32 s74, s73, 7
    s_min_u32 s78, s77, 6
    s_add_u32 s78, s78, s74
    s_mul_i32 s78, s78, 57344
    s_add_u32 s78, s78, s75
    v_add_u32 v12, 4096, v23
    s_waitcnt vmcnt(9)
    v_readfirstlane_b32 s38, v37
    s_barrier
    s_mul_i32 s38, s38, 2654435761
    s_add_u32 s38, s38, 2135587861
    v_mov_b32 v37, s38
    s_lshl_b32 s80, s3, 12
    v_lshl_add_u32 v4, v1, 2, s80
    v_lshl_add_u32 v5, v1, 6, s80
    v_mov_b32 v160, 0
    v_mov_b32 v161, 0
    v_mov_b32 v162, 0
    v_mov_b32 v163, 0
    v_mov_b32 v164, 0
    v_mov_b32 v165, 0
    v_mov_b32 v166, 0
    v_mov_b32 v167, 0
    v_mov_b32 v168, 0
    v_mov_b32 v169, 0
    v_mov_b32 v170, 0
    v_mov_b32 v171, 0
    v_mov_b32 v172, 0
    v_mov_b32 v173, 0
    v_mov_b32 v174, 0
    v_mov_b32 v175, 0
    v_dot2c_f32_bf16 v160, v64, v60
    v_dot2c_f32_bf16 v161, v68, v60
    v_dot2c_f32_bf16 v162, v72, v60
    v_dot2c_f32_bf16 v163, v76, v60
    v_dot2c_f32_bf16 v164, v80, v60
    v_dot2c_f32_bf16 v165, v84, v60
    v_dot2c_f32_bf16 v166, v88, v60
    v_dot2c_f32_bf16 v167, v92, v60
    v_dot2c_f32_bf16 v168, v96, v60
    v_dot2c_f32_bf16 v169, v100, v60
    v_dot2c_f32_bf16 v170, v104, v60
    v_dot2c_f32_bf16 v171, v108, v60
    v_dot2c_f32_bf16 v172, v112, v60
    v_dot2c_f32_bf16 v173, v116, v60
    v_dot2c_f32_bf16 v174, v120, v60
    v_dot2c_f32_bf16 v175, v124, v60
    v_dot2c_f32_bf16 v160, v65, v61
    v_dot2c_f32_bf16 v161, v69, v61
    v_dot2c_f32_bf16 v162, v73, v61
    v_dot2c_f32_bf16 v163, v77, v61
    v_dot2c_f32_bf16 v164, v81, v61
    v_dot2c_f32_bf16 v165, v85, v61
    v_dot2c_f32_bf16 v166, v89, v61
    v_dot2c_f32_bf16 v167, v93, v61
    v_dot2c_f32_bf16 v168, v97, v61
    v_dot2c_f32_bf16 v169, v101, v61
    v_dot2c_f32_bf16 v170, v105, v61
    v_dot2c_f32_bf16 v171, v109, v61
    v_dot2c_f32_bf16 v172, v113, v61
    v_dot2c_f32_bf16 v173, v117, v61
    v_dot2c_f32_bf16 v174, v121, v61
    v_dot2c_f32_bf16 v175, v125, v61
    v_dot2c_f32_bf16 v160, v66, v62
    v_dot2c_f32_bf16 v161, v70, v62
    v_dot2c_f32_bf16 v162, v74, v62
    v_dot2c_f32_bf16 v163, v78, v62
    v_dot2c_f32_bf16 v164, v82, v62
    v_dot2c_f32_bf16 v165, v86, v62
    v_dot2c_f32_bf16 v166, v90, v62
    v_dot2c_f32_bf16 v167, v94, v62
    v_dot2c_f32_bf16 v168, v98, v62
    v_dot2c_f32_bf16 v169, v102, v62
    v_dot2c_f32_bf16 v170, v106, v62
    v_dot2c_f32_bf16 v171, v110, v62
    v_dot2c_f32_bf16 v172, v114, v62
    v_dot2c_f32_bf16 v173, v118, v62
    v_dot2c_f32_bf16 v174, v122, v62
    v_dot2c_f32_bf16 v175, v126, v62
    v_dot2c_f32_bf16 v160, v67, v63
    v_dot2c_f32_bf16 v161, v71, v63
    v_dot2c_f32_bf16 v162, v75, v63
    v_dot2c_f32_bf16 v163, v79, v63
    v_dot2c_f32_bf16 v164, v83, v63
    v_dot2c_f32_bf16 v165, v87, v63
    v_dot2c_f32_bf16 v166, v91, v63
    v_dot2c_f32_bf16 v167, v95, v63
    v_dot2c_f32_bf16 v168, v99, v63
    v_dot2c_f32_bf16 v169, v103, v63
    v_dot2c_f32_bf16 v170, v107, v63
    v_dot2c_f32_bf16 v171, v111, v63
    v_dot2c_f32_bf16 v172, v115, v63
    v_dot2c_f32_bf16 v173, v119, v63
    v_dot2c_f32_bf16 v174, v123, v63
    v_dot2c_f32_bf16 v175, v127, v63
    ds_write_b32 v4, v160 offset:0
    ds_write_b32 v4, v161 offset:256
    ds_write_b32 v4, v162 offset:512
    ds_write_b32 v4, v163 offset:768
    ds_write_b32 v4, v164 offset:1024
    ds_write_b32 v4, v165 offset:1280
    ds_write_b32 v4, v166 offset:1536
    ds_write_b32 v4, v167 offset:1792
    ds_write_b32 v4, v168 offset:2048
    ds_write_b32 v4, v169 offset:2304
    ds_write_b32 v4, v170 offset:2560
    ds_write_b32 v4, v171 offset:2816
    ds_write_b32 v4, v172 offset:3072
    ds_write_b32 v4, v173 offset:3328
    ds_write_b32 v4, v174 offset:3584
    ds_write_b32 v4, v175 offset:3840
    ds_read_b128 v[176:179], v5 offset:0
    ds_read_b128 v[180:183], v5 offset:16
    ds_read_b128 v[184:187], v5 offset:32
    ds_read_b128 v[188:191], v5 offset:48
    s_waitcnt lgkmcnt(0)
    v_add_f32 v176, v176, v184
    v_add_f32 v177, v177, v185
    v_add_f32 v178, v178, v186
    v_add_f32 v179, v179, v187
    v_add_f32 v180, v180, v188
    v_add_f32 v181, v181, v189
    v_add_f32 v182, v182, v190
    v_add_f32 v183, v183, v191
    v_add_f32 v176, v176, v180
    v_add_f32 v177, v177, v181
    v_add_f32 v178, v178, v182
    v_add_f32 v179, v179, v183
    v_add_f32 v176, v176, v178
    v_add_f32 v177, v177, v179
    v_add_f32 v176, v176, v177
    s_nop 1
    v_add_f32_dpp v10, v176, v176 quad_perm:[1,0,3,2] row_mask:0xf bank_mask:0xf
    s_nop 1
    v_add_f32_dpp v10, v10, v10 quad_perm:[2,3,0,1] row_mask:0xf bank_mask:0xf
    v_mul_f32 v10, 0xbfb8aa3b, v10
    v_exp_f32 v10, v10
    s_nop 0
    v_add_f32 v10, 1.0, v10
    v_rcp_f32 v36, v10
    v_and_b32 v5, 3, v1
    v_min_u32 v5, 1, v5
    v_lshlrev_b32 v5, 31, v5
    v_or_b32 v5, v1, v5
    s_lshl_b32 s82, s68, 9
    s_add_u32 s82, s82, 49152
    s_lshl_b32 s81, s3, 6
    s_add_u32 s81, s81, s82
    s_lshl2_add_u32 s82, s3, s82
    buffer_store_dword v36, v5, s[56:59], s81 offen sc1
    v_and_b32 v4, 15, v1
    v_lshrrev_b32 v5, 1, v1
    v_and_or_b32 v4, v5, 16, v4
    v_mul_u32_u24 v4, 1040, v4
    v_and_b32 v5, 16, v1
    v_add_u32 v4, v4, v5
    s_mul_i32 s69, s3, 224
    v_add_u32 v8, s69, v4
    s_and_b32 s72, s67, 28
    s_add_u32 s72, s72, s3
    s_mul_i32 s71, s72, 28672
    s_and_b32 s69, s67, 3
    s_lshl_b32 s76, s69, 10
    s_add_u32 s71, s71, s76
    s_add_u32 s71, s71, 1048576
    s_lshl_b32 s72, s72, 7
    s_lshl2_add_u32 s72, s69, s72
    s_waitcnt vmcnt(1)
    s_barrier
    s_cmp_ge_u32 s66, 28
    s_cbranch_scc1 L_sp_gate
    ds_read_b128 v[128:131], v8 offset:16384
    ds_read_b128 v[132:135], v8 offset:16416
    ds_read_b128 v[136:139], v8 offset:16448
    ds_read_b128 v[140:143], v8 offset:16480
    ds_read_b128 v[144:147], v8 offset:16512
    ds_read_b128 v[148:151], v8 offset:16544
    ds_read_b128 v[152:155], v8 offset:16576
    s_waitcnt lgkmcnt(6)
    buffer_store_dwordx4 v[128:131], v23, s[56:59], s71 offen sc1
    s_add_u32 s71, s71, 4096
    s_waitcnt lgkmcnt(5)
    buffer_store_dwordx4 v[132:135], v23, s[56:59], s71 offen sc1
    s_add_u32 s71, s71, 4096
    s_waitcnt lgkmcnt(4)
    buffer_store_dwordx4 v[136:139], v23, s[56:59], s71 offen sc1
    s_add_u32 s71, s71, 4096
    s_waitcnt lgkmcnt(3)
    buffer_store_dwordx4 v[140:143], v23, s[56:59], s71 offen sc1
    s_add_u32 s71, s71, 4096
    s_waitcnt lgkmcnt(2)
    buffer_store_dwordx4 v[144:147], v23, s[56:59], s71 offen sc1
    s_add_u32 s71, s71, 4096
    s_waitcnt lgkmcnt(1)
    buffer_store_dwordx4 v[148:151], v23, s[56:59], s71 offen sc1
    s_add_u32 s71, s71, 4096
    s_waitcnt lgkmcnt(0)
    buffer_store_dwordx4 v[152:155], v23, s[56:59], s71 offen sc1
    s_add_u32 s71, s71, 4096
    buffer_load_dwordx4 v[252:255], v23, s[52:55], s78 offen offset:0
    buffer_load_dwordx4 v[252:255], v23, s[52:55], s78 offen offset:1024
    buffer_load_dwordx4 v[252:255], v23, s[52:55], s78 offen offset:2048
    buffer_load_dwordx4 v[252:255], v23, s[52:55], s78 offen offset:3072
    buffer_load_dwordx4 v[252:255], v12, s[52:55], s78 offen offset:0
    buffer_load_dwordx4 v[252:255], v12, s[52:55], s78 offen offset:1024
    buffer_load_dwordx4 v[252:255], v12, s[52:55], s78 offen offset:2048
    s_waitcnt vmcnt(7)
    s_atomic_swap s38, s[36:37], s72 offset:4096
    s_branch L_sp_w
L_sp_gate:
    buffer_load_dwordx4 v[252:255], v23, s[52:55], s78 offen offset:0
    buffer_load_dwordx4 v[252:255], v23, s[52:55], s78 offen offset:1024
    buffer_load_dwordx4 v[252:255], v23, s[52:55], s78 offen offset:2048
    buffer_load_dwordx4 v[252:255], v23, s[52:55], s78 offen offset:3072
    buffer_load_dwordx4 v[252:255], v12, s[52:55], s78 offen offset:0
    buffer_load_dwordx4 v[252:255], v12, s[52:55], s78 offen offset:1024
    buffer_load_dwordx4 v[252:255], v12, s[52:55], s78 offen offset:2048
    s_waitcnt vmcnt(7)
L_sp_w:
    s_atomic_swap s38, s[36:37], s82 offset:256
    s_add_u32 s78, s78, 28672
    buffer_load_dwordx4 v[252:255], v23, s[52:55], s78 offen offset:0
    buffer_load_dwordx4 v[252:255], v23, s[52:55], s78 offen offset:1024
    buffer_load_dwordx4 v[252:255], v23, s[52:55], s78 offen offset:2048
    buffer_load_dwordx4 v[252:255], v23, s[52:55], s78 offen offset:3072
    buffer_load_dwordx4 v[252:255], v12, s[52:55], s78 offen offset:0
    buffer_load_dwordx4 v[252:255], v12, s[52:55], s78 offen offset:1024
    buffer_load_dwordx4 v[252:255], v12, s[52:55], s78 offen offset:2048
    s_mov_b32 s83, s66
    s_lshl1_add_u32 s71, s73, s77
    s_mul_i32 s69, s71, 37
    s_lshr_b32 s69, s69, 8
    s_mul_i32 s69, s69, 7
    s_sub_u32 s69, s71, s69
    s_lshl_b32 s60, s69, 7
    s_add_u32 s61, s60, 128
    s_cmp_eq_u32 s61, 896
    s_cselect_b32 s61, 0, s61
    s_add_u32 s62, s61, 128
    s_cmp_eq_u32 s62, 896
    s_cselect_b32 s62, 0, s62
    s_add_u32 s63, s62, 128
    s_cmp_eq_u32 s63, 896
    s_cselect_b32 s63, 0, s63
    s_add_u32 s64, s63, 128
    s_cmp_eq_u32 s64, 896
    s_cselect_b32 s64, 0, s64
    s_add_u32 s65, s64, 128
    s_cmp_eq_u32 s65, 896
    s_cselect_b32 s65, 0, s65
    s_add_u32 s66, s65, 128
    s_cmp_eq_u32 s66, 896
    s_cselect_b32 s66, 0, s66
    s_mul_i32 s69, s3, 7
    s_add_u32 s69, s69, 5
    s_mul_i32 s71, s69, 57344
    s_add_u32 s52, s28, s71
    s_addc_u32 s53, s29, 0
    s_mul_i32 s71, s68, 84
    s_add_u32 s71, s71, s69
    s_lshl_b32 s71, s71, 12
    s_add_u32 s71, s71, 2097152
    s_mul_i32 s72, s3, 8192
    s_lshl3_add_u32 s89, s68, s3
    s_lshl_b32 s89, s89, 7
    s_add_u32 s89, s89, 8192
    s_mul_i32 s74, s68, 28
    s_add_u32 s74, s74, s3
    s_lshl_b32 s74, s74, 11
    s_add_u32 s74, s74, 13631488
    s_mov_b32 s39, s38
    v_lshrrev_b32 v2, 3, v1
    v_and_b32 v3, 7, v1
    v_lshrrev_b32 v4, 4, v1
    v_lshlrev_b32 v5, 1, v4
    v_xor_b32 v5, v3, v5
    v_mul_u32_u24 v6, 896, v2
    v_lshl_add_u32 v19, v5, 4, v6
    v_add_u32 v20, 6144, v19
    v_add_u32 v21, 12288, v19
    v_add_u32 v22, 18432, v19
    v_and_b32 v5, 3, v2
    v_xor_b32 v5, s3, v5
    v_lshlrev_b32 v5, 5, v5
    v_and_b32 v6, 3, v1
    v_lshl_add_u32 v5, v6, 3, v5
    v_lshrrev_b32 v7, 2, v1
    v_lshl_add_u32 v24, v7, 7, v5
    v_add_u32 v25, 32768, v24
    v_add_u32 v26, 65536, v24
    v_add_u32 v27, 65536, v23
    v_lshl_add_u32 v5, s3, 2, v4
    v_xor_b32 v7, v5, v3
    v_lshlrev_b32 v7, 4, v7
    v_lshl_add_u32 v7, v6, 8, v7
    v_bfe_u32 v6, v1, 2, 2
    v_lshl_add_u32 v7, v6, 11, v7
    v_add_u32 v28, 147456, v7
    v_and_b32 v5, 7, v5
    v_xor_b32 v5, v1, v5
    v_lshlrev_b32 v5, 4, v5
    v_lshl_add_u32 v5, s3, 11, v5
    v_add_u32 v29, 147456, v5
    s_barrier
    s_lshl_b32 s76, s3, 14
    s_add_u32 s76, s76, 98304
    v_add_u32 v30, s76, v23
    v_lshlrev_b32 v128, 16, v56
    s_add_u32 m0, s72, 0
    v_and_b32 v129, 0xffff0000, v56
    v_lshlrev_b32 v130, 16, v57
    v_and_b32 v131, 0xffff0000, v57
    v_lshlrev_b32 v132, 16, v58
    v_and_b32 v133, 0xffff0000, v58
    v_lshlrev_b32 v134, 16, v59
    v_and_b32 v135, 0xffff0000, v59
    v_readlane_b32 s80, v36, 0
    s_add_u32 s69, s60, 0
    v_xor_b32 v31, 0, v30
    v_lshlrev_b32 v136, 16, v64
    v_and_b32 v137, 0xffff0000, v64
    v_lshlrev_b32 v138, 16, v65
    v_and_b32 v139, 0xffff0000, v65
    v_lshlrev_b32 v140, 16, v66
    v_and_b32 v141, 0xffff0000, v66
    v_lshlrev_b32 v142, 16, v67
    buffer_load_dwordx4 v19, s[52:55], s69 offen offset:0 lds
    v_and_b32 v143, 0xffff0000, v67
    v_pk_mul_f32 v[136:137], v[136:137], v[128:129]
    v_pk_mul_f32 v[138:139], v[138:139], v[130:131]
    v_pk_mul_f32 v[140:141], v[140:141], v[132:133]
    v_pk_mul_f32 v[142:143], v[142:143], v[134:135]
    v_pk_mul_f32 v[136:137], v[136:137], s[80:81] op_sel_hi:[1,0]
    v_pk_mul_f32 v[138:139], v[138:139], s[80:81] op_sel_hi:[1,0]
    v_pk_mul_f32 v[140:141], v[140:141], s[80:81] op_sel_hi:[1,0]
    buffer_load_dwordx4 v20, s[52:55], s69 offen offset:1024 lds
    v_pk_mul_f32 v[142:143], v[142:143], s[80:81] op_sel_hi:[1,0]
    v_cvt_pk_bf16_f32 v64, v136, v137
    v_cvt_pk_bf16_f32 v65, v138, v139
    v_cvt_pk_bf16_f32 v66, v140, v141
    v_cvt_pk_bf16_f32 v67, v142, v143
    ds_write_b128 v31, v[64:67] offset:0
    v_readlane_b32 s80, v36, 4
    buffer_load_dwordx4 v21, s[52:55], s69 offen offset:2048 lds
    v_xor_b32 v31, 16, v30
    v_lshlrev_b32 v136, 16, v68
    v_and_b32 v137, 0xffff0000, v68
    v_lshlrev_b32 v138, 16, v69
    v_and_b32 v139, 0xffff0000, v69
    v_lshlrev_b32 v140, 16, v70
    v_and_b32 v141, 0xffff0000, v70
    v_lshlrev_b32 v142, 16, v71
    buffer_load_dwordx4 v22, s[52:55], s69 offen offset:3072 lds
    v_and_b32 v143, 0xffff0000, v71
    v_pk_mul_f32 v[136:137], v[136:137], v[128:129]
    v_pk_mul_f32 v[138:139], v[138:139], v[130:131]
    v_pk_mul_f32 v[140:141], v[140:141], v[132:133]
    v_pk_mul_f32 v[142:143], v[142:143], v[134:135]
    v_pk_mul_f32 v[136:137], v[136:137], s[80:81] op_sel_hi:[1,0]
    v_pk_mul_f32 v[138:139], v[138:139], s[80:81] op_sel_hi:[1,0]
    v_pk_mul_f32 v[140:141], v[140:141], s[80:81] op_sel_hi:[1,0]
    s_add_u32 m0, s72, 4096
    v_pk_mul_f32 v[142:143], v[142:143], s[80:81] op_sel_hi:[1,0]
    v_cvt_pk_bf16_f32 v68, v136, v137
    v_cvt_pk_bf16_f32 v69, v138, v139
    v_cvt_pk_bf16_f32 v70, v140, v141
    v_cvt_pk_bf16_f32 v71, v142, v143
    ds_write_b128 v31, v[68:71] offset:1024
    v_readlane_b32 s80, v36, 8
    v_xor_b32 v31, 32, v30
    s_add_u32 s69, s60, 57344
    v_lshlrev_b32 v136, 16, v72
    v_and_b32 v137, 0xffff0000, v72
    v_lshlrev_b32 v138, 16, v73
    v_and_b32 v139, 0xffff0000, v73
    v_lshlrev_b32 v140, 16, v74
    v_and_b32 v141, 0xffff0000, v74
    v_lshlrev_b32 v142, 16, v75
    v_and_b32 v143, 0xffff0000, v75
    buffer_load_dwordx4 v19, s[52:55], s69 offen offset:0 lds
    v_pk_mul_f32 v[136:137], v[136:137], v[128:129]
    v_pk_mul_f32 v[138:139], v[138:139], v[130:131]
    v_pk_mul_f32 v[140:141], v[140:141], v[132:133]
    v_pk_mul_f32 v[142:143], v[142:143], v[134:135]
    v_pk_mul_f32 v[136:137], v[136:137], s[80:81] op_sel_hi:[1,0]
    v_pk_mul_f32 v[138:139], v[138:139], s[80:81] op_sel_hi:[1,0]
    v_pk_mul_f32 v[140:141], v[140:141], s[80:81] op_sel_hi:[1,0]
    v_pk_mul_f32 v[142:143], v[142:143], s[80:81] op_sel_hi:[1,0]
    buffer_load_dwordx4 v20, s[52:55], s69 offen offset:1024 lds
    v_cvt_pk_bf16_f32 v72, v136, v137
    v_cvt_pk_bf16_f32 v73, v138, v139
    v_cvt_pk_bf16_f32 v74, v140, v141
    v_cvt_pk_bf16_f32 v75, v142, v143
    ds_write_b128 v31, v[72:75] offset:2048
    v_readlane_b32 s80, v36, 12
    v_xor_b32 v31, 48, v30
    v_lshlrev_b32 v136, 16, v76
    buffer_load_dwordx4 v21, s[52:55], s69 offen offset:2048 lds
    v_and_b32 v137, 0xffff0000, v76
    v_lshlrev_b32 v138, 16, v77
    v_and_b32 v139, 0xffff0000, v77
    v_lshlrev_b32 v140, 16, v78
    v_and_b32 v141, 0xffff0000, v78
    v_lshlrev_b32 v142, 16, v79
    v_and_b32 v143, 0xffff0000, v79
    v_pk_mul_f32 v[136:137], v[136:137], v[128:129]
    buffer_load_dwordx4 v22, s[52:55], s69 offen offset:3072 lds
    v_pk_mul_f32 v[138:139], v[138:139], v[130:131]
    v_pk_mul_f32 v[140:141], v[140:141], v[132:133]
    v_pk_mul_f32 v[142:143], v[142:143], v[134:135]
    v_pk_mul_f32 v[136:137], v[136:137], s[80:81] op_sel_hi:[1,0]
    v_pk_mul_f32 v[138:139], v[138:139], s[80:81] op_sel_hi:[1,0]
    v_pk_mul_f32 v[140:141], v[140:141], s[80:81] op_sel_hi:[1,0]
    v_pk_mul_f32 v[142:143], v[142:143], s[80:81] op_sel_hi:[1,0]
    s_add_u32 m0, s72, 32768
    v_cvt_pk_bf16_f32 v76, v136, v137
    v_cvt_pk_bf16_f32 v77, v138, v139
    v_cvt_pk_bf16_f32 v78, v140, v141
    v_cvt_pk_bf16_f32 v79, v142, v143
    ds_write_b128 v31, v[76:79] offset:3072
    v_readlane_b32 s80, v36, 16
    v_xor_b32 v31, 64, v30
    v_lshlrev_b32 v136, 16, v80
    s_add_u32 s69, s61, 0
    v_and_b32 v137, 0xffff0000, v80
    v_lshlrev_b32 v138, 16, v81
    v_and_b32 v139, 0xffff0000, v81
    v_lshlrev_b32 v140, 16, v82
    v_and_b32 v141, 0xffff0000, v82
    v_lshlrev_b32 v142, 16, v83
    v_and_b32 v143, 0xffff0000, v83
    v_pk_mul_f32 v[136:137], v[136:137], v[128:129]
    buffer_load_dwordx4 v19, s[52:55], s69 offen offset:0 lds
    v_pk_mul_f32 v[138:139], v[138:139], v[130:131]
    v_pk_mul_f32 v[140:141], v[140:141], v[132:133]
    v_pk_mul_f32 v[142:143], v[142:143], v[134:135]
    v_pk_mul_f32 v[136:137], v[136:137], s[80:81] op_sel_hi:[1,0]
    v_pk_mul_f32 v[138:139], v[138:139], s[80:81] op_sel_hi:[1,0]
    v_pk_mul_f32 v[140:141], v[140:141], s[80:81] op_sel_hi:[1,0]
    v_pk_mul_f32 v[142:143], v[142:143], s[80:81] op_sel_hi:[1,0]
    v_cvt_pk_bf16_f32 v80, v136, v137
    buffer_load_dwordx4 v20, s[52:55], s69 offen offset:1024 lds
    v_cvt_pk_bf16_f32 v81, v138, v139
    v_cvt_pk_bf16_f32 v82, v140, v141
    v_cvt_pk_bf16_f32 v83, v142, v143
    ds_write_b128 v31, v[80:83] offset:4096
    v_readlane_b32 s80, v36, 20
    v_xor_b32 v31, 80, v30
    v_lshlrev_b32 v136, 16, v84
    v_and_b32 v137, 0xffff0000, v84
    buffer_load_dwordx4 v21, s[52:55], s69 offen offset:2048 lds
    v_lshlrev_b32 v138, 16, v85
    v_and_b32 v139, 0xffff0000, v85
    v_lshlrev_b32 v140, 16, v86
    v_and_b32 v141, 0xffff0000, v86
    v_lshlrev_b32 v142, 16, v87
    v_and_b32 v143, 0xffff0000, v87
    v_pk_mul_f32 v[136:137], v[136:137], v[128:129]
    v_pk_mul_f32 v[138:139], v[138:139], v[130:131]
    buffer_load_dwordx4 v22, s[52:55], s69 offen offset:3072 lds
    v_pk_mul_f32 v[140:141], v[140:141], v[132:133]
    v_pk_mul_f32 v[142:143], v[142:143], v[134:135]
    v_pk_mul_f32 v[136:137], v[136:137], s[80:81] op_sel_hi:[1,0]
    v_pk_mul_f32 v[138:139], v[138:139], s[80:81] op_sel_hi:[1,0]
    v_pk_mul_f32 v[140:141], v[140:141], s[80:81] op_sel_hi:[1,0]
    v_pk_mul_f32 v[142:143], v[142:143], s[80:81] op_sel_hi:[1,0]
    v_cvt_pk_bf16_f32 v84, v136, v137
    v_cvt_pk_bf16_f32 v85, v138, v139
    s_add_u32 m0, s72, 36864
    v_cvt_pk_bf16_f32 v86, v140, v141
    v_cvt_pk_bf16_f32 v87, v142, v143
    ds_write_b128 v31, v[84:87] offset:5120
    v_readlane_b32 s80, v36, 24
    v_xor_b32 v31, 96, v30
    v_lshlrev_b32 v136, 16, v88
    v_and_b32 v137, 0xffff0000, v88
    v_lshlrev_b32 v138, 16, v89
    s_add_u32 s69, s61, 57344
    v_and_b32 v139, 0xffff0000, v89
    v_lshlrev_b32 v140, 16, v90
    v_and_b32 v141, 0xffff0000, v90
    v_lshlrev_b32 v142, 16, v91
    v_and_b32 v143, 0xffff0000, v91
    v_pk_mul_f32 v[136:137], v[136:137], v[128:129]
    v_pk_mul_f32 v[138:139], v[138:139], v[130:131]
    buffer_load_dwordx4 v19, s[52:55], s69 offen offset:0 lds
    v_pk_mul_f32 v[140:141], v[140:141], v[132:133]
    v_pk_mul_f32 v[142:143], v[142:143], v[134:135]
    v_pk_mul_f32 v[136:137], v[136:137], s[80:81] op_sel_hi:[1,0]
    v_pk_mul_f32 v[138:139], v[138:139], s[80:81] op_sel_hi:[1,0]
    v_pk_mul_f32 v[140:141], v[140:141], s[80:81] op_sel_hi:[1,0]
    v_pk_mul_f32 v[142:143], v[142:143], s[80:81] op_sel_hi:[1,0]
    v_cvt_pk_bf16_f32 v88, v136, v137
    v_cvt_pk_bf16_f32 v89, v138, v139
    buffer_load_dwordx4 v20, s[52:55], s69 offen offset:1024 lds
    v_cvt_pk_bf16_f32 v90, v140, v141
    v_cvt_pk_bf16_f32 v91, v142, v143
    ds_write_b128 v31, v[88:91] offset:6144
    v_readlane_b32 s80, v36, 28
    v_xor_b32 v31, 112, v30
    v_lshlrev_b32 v136, 16, v92
    v_and_b32 v137, 0xffff0000, v92
    v_lshlrev_b32 v138, 16, v93
    buffer_load_dwordx4 v21, s[52:55], s69 offen offset:2048 lds
    v_and_b32 v139, 0xffff0000, v93
    v_lshlrev_b32 v140, 16, v94
    v_and_b32 v141, 0xffff0000, v94
    v_lshlrev_b32 v142, 16, v95
    v_and_b32 v143, 0xffff0000, v95
    v_pk_mul_f32 v[136:137], v[136:137], v[128:129]
    v_pk_mul_f32 v[138:139], v[138:139], v[130:131]
    v_pk_mul_f32 v[140:141], v[140:141], v[132:133]
    buffer_load_dwordx4 v22, s[52:55], s69 offen offset:3072 lds
    v_pk_mul_f32 v[142:143], v[142:143], v[134:135]
    v_pk_mul_f32 v[136:137], v[136:137], s[80:81] op_sel_hi:[1,0]
    v_pk_mul_f32 v[138:139], v[138:139], s[80:81] op_sel_hi:[1,0]
    v_pk_mul_f32 v[140:141], v[140:141], s[80:81] op_sel_hi:[1,0]
    s_waitcnt vmcnt(8)
    s_barrier
    v_pk_mul_f32 v[142:143], v[142:143], s[80:81] op_sel_hi:[1,0]
    v_cvt_pk_bf16_f32 v92, v136, v137
    v_cvt_pk_bf16_f32 v93, v138, v139
    v_cvt_pk_bf16_f32 v94, v140, v141
    v_cvt_pk_bf16_f32 v95, v142, v143
    ds_write_b128 v31, v[92:95] offset:7168
    ds_read_b64_tr_b16 a[128:129], v24 offset:0
    v_readlane_b32 s80, v36, 32
    v_xor_b32 v31, 0, v30
    s_add_u32 m0, s72, 65536
    v_lshlrev_b32 v136, 16, v96
    v_and_b32 v137, 0xffff0000, v96
    v_lshlrev_b32 v138, 16, v97
    v_and_b32 v139, 0xffff0000, v97
    v_lshlrev_b32 v140, 16, v98
    v_and_b32 v141, 0xffff0000, v98
    v_lshlrev_b32 v142, 16, v99
    v_and_b32 v143, 0xffff0000, v99
    v_pk_mul_f32 v[136:137], v[136:137], v[128:129]
    v_pk_mul_f32 v[138:139], v[138:139], v[130:131]
    ds_read_b64_tr_b16 a[130:131], v24 offset:2048
    v_pk_mul_f32 v[140:141], v[140:141], v[132:133]
    v_pk_mul_f32 v[142:143], v[142:143], v[134:135]
    v_pk_mul_f32 v[136:137], v[136:137], s[80:81] op_sel_hi:[1,0]
    v_pk_mul_f32 v[138:139], v[138:139], s[80:81] op_sel_hi:[1,0]
    v_pk_mul_f32 v[140:141], v[140:141], s[80:81] op_sel_hi:[1,0]
    v_pk_mul_f32 v[142:143], v[142:143], s[80:81] op_sel_hi:[1,0]
    s_add_u32 s69, s62, 0
    v_cvt_pk_bf16_f32 v96, v136, v137
    v_cvt_pk_bf16_f32 v97, v138, v139
    v_cvt_pk_bf16_f32 v98, v140, v141
    v_cvt_pk_bf16_f32 v99, v142, v143
    ds_write_b128 v31, v[96:99] offset:8192
    v_readlane_b32 s80, v36, 36
    ds_read_b64_tr_b16 a[132:133], v24 offset:4096
    v_xor_b32 v31, 16, v30
    v_lshlrev_b32 v136, 16, v100
    v_and_b32 v137, 0xffff0000, v100
    v_lshlrev_b32 v138, 16, v101
    v_and_b32 v139, 0xffff0000, v101
    v_lshlrev_b32 v140, 16, v102
    v_and_b32 v141, 0xffff0000, v102
    v_lshlrev_b32 v142, 16, v103
    v_and_b32 v143, 0xffff0000, v103
    v_pk_mul_f32 v[136:137], v[136:137], v[128:129]
    buffer_load_dwordx4 v19, s[52:55], s69 offen offset:0 lds
    v_pk_mul_f32 v[138:139], v[138:139], v[130:131]
    v_pk_mul_f32 v[140:141], v[140:141], v[132:133]
    ds_read_b64_tr_b16 a[134:135], v24 offset:6144
    v_pk_mul_f32 v[142:143], v[142:143], v[134:135]
    v_pk_mul_f32 v[136:137], v[136:137], s[80:81] op_sel_hi:[1,0]
    v_pk_mul_f32 v[138:139], v[138:139], s[80:81] op_sel_hi:[1,0]
    v_pk_mul_f32 v[140:141], v[140:141], s[80:81] op_sel_hi:[1,0]
    v_pk_mul_f32 v[142:143], v[142:143], s[80:81] op_sel_hi:[1,0]
    v_cvt_pk_bf16_f32 v100, v136, v137
    v_cvt_pk_bf16_f32 v101, v138, v139
    v_cvt_pk_bf16_f32 v102, v140, v141
    v_cvt_pk_bf16_f32 v103, v142, v143
    ds_write_b128 v31, v[100:103] offset:9216
    v_readlane_b32 s80, v36, 40
    ds_read_b64_tr_b16 a[136:137], v24 offset:8192
    v_xor_b32 v31, 32, v30
    v_lshlrev_b32 v136, 16, v104
    buffer_load_dwordx4 v20, s[52:55], s69 offen offset:1024 lds
    v_and_b32 v137, 0xffff0000, v104
    v_lshlrev_b32 v138, 16, v105
    v_and_b32 v139, 0xffff0000, v105
    v_lshlrev_b32 v140, 16, v106
    v_and_b32 v141, 0xffff0000, v106
    v_lshlrev_b32 v142, 16, v107
    v_and_b32 v143, 0xffff0000, v107
    v_pk_mul_f32 v[136:137], v[136:137], v[128:129]
    v_pk_mul_f32 v[138:139], v[138:139], v[130:131]
    v_pk_mul_f32 v[140:141], v[140:141], v[132:133]
    ds_read_b64_tr_b16 a[138:139], v24 offset:10240
    v_pk_mul_f32 v[142:143], v[142:143], v[134:135]
    v_pk_mul_f32 v[136:137], v[136:137], s[80:81] op_sel_hi:[1,0]
    v_pk_mul_f32 v[138:139], v[138:139], s[80:81] op_sel_hi:[1,0]
    v_pk_mul_f32 v[140:141], v[140:141], s[80:81] op_sel_hi:[1,0]
    v_pk_mul_f32 v[142:143], v[142:143], s[80:81] op_sel_hi:[1,0]
    v_cvt_pk_bf16_f32 v104, v136, v137
    buffer_load_dwordx4 v21, s[52:55], s69 offen offset:2048 lds
    v_cvt_pk_bf16_f32 v105, v138, v139
    v_cvt_pk_bf16_f32 v106, v140, v141
    v_cvt_pk_bf16_f32 v107, v142, v143
    ds_write_b128 v31, v[104:107] offset:10240
    v_readlane_b32 s80, v36, 44
    v_xor_b32 v31, 48, v30
    ds_read_b64_tr_b16 a[140:141], v24 offset:12288
    v_lshlrev_b32 v136, 16, v108
    v_and_b32 v137, 0xffff0000, v108
    v_lshlrev_b32 v138, 16, v109
    v_and_b32 v139, 0xffff0000, v109
    v_lshlrev_b32 v140, 16, v110
    v_and_b32 v141, 0xffff0000, v110
    v_lshlrev_b32 v142, 16, v111
    v_and_b32 v143, 0xffff0000, v111
    v_pk_mul_f32 v[136:137], v[136:137], v[128:129]
    v_pk_mul_f32 v[138:139], v[138:139], v[130:131]
    buffer_load_dwordx4 v22, s[52:55], s69 offen offset:3072 lds
    v_pk_mul_f32 v[140:141], v[140:141], v[132:133]
    v_pk_mul_f32 v[142:143], v[142:143], v[134:135]
    ds_read_b64_tr_b16 a[142:143], v24 offset:14336
    v_pk_mul_f32 v[136:137], v[136:137], s[80:81] op_sel_hi:[1,0]
    v_pk_mul_f32 v[138:139], v[138:139], s[80:81] op_sel_hi:[1,0]
    v_pk_mul_f32 v[140:141], v[140:141], s[80:81] op_sel_hi:[1,0]
    v_pk_mul_f32 v[142:143], v[142:143], s[80:81] op_sel_hi:[1,0]
    v_cvt_pk_bf16_f32 v108, v136, v137
    v_cvt_pk_bf16_f32 v109, v138, v139
    v_cvt_pk_bf16_f32 v110, v140, v141
    v_cvt_pk_bf16_f32 v111, v142, v143
    ds_write_b128 v31, v[108:111] offset:11264
    v_readlane_b32 s80, v36, 48
    v_xor_b32 v31, 64, v30
    v_lshlrev_b32 v136, 16, v112
    ds_read_b64_tr_b16 a[144:145], v24 offset:16384
    v_and_b32 v137, 0xffff0000, v112
    v_lshlrev_b32 v138, 16, v113
    s_add_u32 m0, s72, 69632
    v_and_b32 v139, 0xffff0000, v113
    v_lshlrev_b32 v140, 16, v114
    v_and_b32 v141, 0xffff0000, v114
    v_lshlrev_b32 v142, 16, v115
    v_and_b32 v143, 0xffff0000, v115
    v_pk_mul_f32 v[136:137], v[136:137], v[128:129]
    v_pk_mul_f32 v[138:139], v[138:139], v[130:131]
    v_pk_mul_f32 v[140:141], v[140:141], v[132:133]
    v_pk_mul_f32 v[142:143], v[142:143], v[134:135]
    v_pk_mul_f32 v[136:137], v[136:137], s[80:81] op_sel_hi:[1,0]
    ds_read_b64_tr_b16 a[146:147], v24 offset:18432
    v_pk_mul_f32 v[138:139], v[138:139], s[80:81] op_sel_hi:[1,0]
    v_pk_mul_f32 v[140:141], v[140:141], s[80:81] op_sel_hi:[1,0]
    v_pk_mul_f32 v[142:143], v[142:143], s[80:81] op_sel_hi:[1,0]
    v_cvt_pk_bf16_f32 v112, v136, v137
    v_cvt_pk_bf16_f32 v113, v138, v139
    v_cvt_pk_bf16_f32 v114, v140, v141
    s_add_u32 s69, s62, 57344
    v_cvt_pk_bf16_f32 v115, v142, v143
    ds_write_b128 v31, v[112:115] offset:12288
    v_readlane_b32 s80, v36, 52
    v_xor_b32 v31, 80, v30
    v_lshlrev_b32 v136, 16, v116
    v_and_b32 v137, 0xffff0000, v116
    ds_read_b64_tr_b16 a[148:149], v24 offset:20480
    v_lshlrev_b32 v138, 16, v117
    v_and_b32 v139, 0xffff0000, v117
    v_lshlrev_b32 v140, 16, v118
    v_and_b32 v141, 0xffff0000, v118
    v_lshlrev_b32 v142, 16, v119
    v_and_b32 v143, 0xffff0000, v119
    v_pk_mul_f32 v[136:137], v[136:137], v[128:129]
    v_pk_mul_f32 v[138:139], v[138:139], v[130:131]
    v_pk_mul_f32 v[140:141], v[140:141], v[132:133]
    v_pk_mul_f32 v[142:143], v[142:143], v[134:135]
    buffer_load_dwordx4 v19, s[52:55], s69 offen offset:0 lds
    v_pk_mul_f32 v[136:137], v[136:137], s[80:81] op_sel_hi:[1,0]
    v_pk_mul_f32 v[138:139], v[138:139], s[80:81] op_sel_hi:[1,0]
    ds_read_b64_tr_b16 a[150:151], v24 offset:22528
    v_pk_mul_f32 v[140:141], v[140:141], s[80:81] op_sel_hi:[1,0]
    v_pk_mul_f32 v[142:143], v[142:143], s[80:81] op_sel_hi:[1,0]
    v_cvt_pk_bf16_f32 v116, v136, v137
    v_cvt_pk_bf16_f32 v117, v138, v139
    v_cvt_pk_bf16_f32 v118, v140, v141
    v_cvt_pk_bf16_f32 v119, v142, v143
    ds_write_b128 v31, v[116:119] offset:13312
    v_readlane_b32 s80, v36, 56
    v_xor_b32 v31, 96, v30
    v_lshlrev_b32 v136, 16, v120
    v_and_b32 v137, 0xffff0000, v120
    ds_read_b64_tr_b16 a[152:153], v24 offset:24576
    v_lshlrev_b32 v138, 16, v121
    v_and_b32 v139, 0xffff0000, v121
    buffer_load_dwordx4 v20, s[52:55], s69 offen offset:1024 lds
    v_lshlrev_b32 v140, 16, v122
    v_and_b32 v141, 0xffff0000, v122
    v_lshlrev_b32 v142, 16, v123
    v_and_b32 v143, 0xffff0000, v123
    v_pk_mul_f32 v[136:137], v[136:137], v[128:129]
    v_pk_mul_f32 v[138:139], v[138:139], v[130:131]
    v_pk_mul_f32 v[140:141], v[140:141], v[132:133]
    v_pk_mul_f32 v[142:143], v[142:143], v[134:135]
    v_pk_mul_f32 v[136:137], v[136:137], s[80:81] op_sel_hi:[1,0]
    v_pk_mul_f32 v[138:139], v[138:139], s[80:81] op_sel_hi:[1,0]
    ds_read_b64_tr_b16 a[154:155], v24 offset:26624
    v_pk_mul_f32 v[140:141], v[140:141], s[80:81] op_sel_hi:[1,0]
    v_pk_mul_f32 v[142:143], v[142:143], s[80:81] op_sel_hi:[1,0]
    v_cvt_pk_bf16_f32 v120, v136, v137
    v_cvt_pk_bf16_f32 v121, v138, v139
    v_cvt_pk_bf16_f32 v122, v140, v141
    v_cvt_pk_bf16_f32 v123, v142, v143
    buffer_load_dwordx4 v21, s[52:55], s69 offen offset:2048 lds
    ds_write_b128 v31, v[120:123] offset:14336
    v_readlane_b32 s80, v36, 60
    v_xor_b32 v31, 112, v30
    v_lshlrev_b32 v136, 16, v124
    v_and_b32 v137, 0xffff0000, v124
    v_lshlrev_b32 v138, 16, v125
    ds_read_b64_tr_b16 a[156:157], v24 offset:28672
    v_and_b32 v139, 0xffff0000, v125
    v_lshlrev_b32 v140, 16, v126
    v_and_b32 v141, 0xffff0000, v126
    v_lshlrev_b32 v142, 16, v127
    v_and_b32 v143, 0xffff0000, v127
    v_pk_mul_f32 v[136:137], v[136:137], v[128:129]
    v_pk_mul_f32 v[138:139], v[138:139], v[130:131]
    v_pk_mul_f32 v[140:141], v[140:141], v[132:133]
    v_pk_mul_f32 v[142:143], v[142:143], v[134:135]
    v_pk_mul_f32 v[136:137], v[136:137], s[80:81] op_sel_hi:[1,0]
    buffer_load_dwordx4 v22, s[52:55], s69 offen offset:3072 lds
    v_pk_mul_f32 v[138:139], v[138:139], s[80:81] op_sel_hi:[1,0]
    v_pk_mul_f32 v[140:141], v[140:141], s[80:81] op_sel_hi:[1,0]
    ds_read_b64_tr_b16 a[158:159], v24 offset:30720
    v_pk_mul_f32 v[142:143], v[142:143], s[80:81] op_sel_hi:[1,0]
    v_cvt_pk_bf16_f32 v124, v136, v137
    v_cvt_pk_bf16_f32 v125, v138, v139
    v_cvt_pk_bf16_f32 v126, v140, v141
    v_cvt_pk_bf16_f32 v127, v142, v143
    ds_write_b128 v31, v[124:127] offset:15360
    s_waitcnt vmcnt(8)
    s_waitcnt lgkmcnt(0)
    s_barrier
    v_lshrrev_b32 v2, 5, v1
    ds_read_b64_tr_b16 a[160:161], v25 offset:0
    v_lshl_add_u32 v2, s3, 1, v2
    s_add_u32 m0, s72, 0
    v_and_b32 v3, 7, v1
    v_xor_b32 v2, v2, v3
    ds_read_b64_tr_b16 a[162:163], v25 offset:2048
    v_lshlrev_b32 v2, 4, v2
    v_and_b32 v3, 15, v1
    s_add_u32 s69, s63, 0
    v_lshl_add_u32 v2, v3, 10, v2
    ds_read_b64_tr_b16 a[164:165], v25 offset:4096
    v_bfe_u32 v3, v1, 4, 1
    v_lshl_add_u32 v2, v3, 3, v2
    buffer_load_dwordx4 v19, s[52:55], s69 offen offset:0 lds
    v_add_u32 v2, 98304, v2
    ds_read_b64_tr_b16 a[166:167], v25 offset:6144
    v_add_u32 v3, s60, v2
    ds_read_b64 v[192:193], v3 offset:0
    ds_read_b64 v[194:195], v3 offset:16384
    ds_read_b64_tr_b16 a[168:169], v25 offset:8192
    buffer_load_dwordx4 v20, s[52:55], s69 offen offset:1024 lds
    ds_read_b64 v[196:197], v3 offset:32768
    ds_read_b64 v[198:199], v3 offset:49152
    ds_read_b64_tr_b16 a[170:171], v25 offset:10240
    v_add_u32 v3, s61, v2
    ds_read_b64 v[200:201], v3 offset:0
    buffer_load_dwordx4 v21, s[52:55], s69 offen offset:2048 lds
    ds_read_b64 v[202:203], v3 offset:16384
    ds_read_b64_tr_b16 a[172:173], v25 offset:12288
    ds_read_b64 v[204:205], v3 offset:32768
    ds_read_b64 v[206:207], v3 offset:49152
    v_add_u32 v3, s62, v2
    buffer_load_dwordx4 v22, s[52:55], s69 offen offset:3072 lds
    ds_read_b64_tr_b16 a[174:175], v25 offset:14336
    ds_read_b64 v[208:209], v3 offset:0
    ds_read_b64 v[210:211], v3 offset:16384
    ds_read_b64 v[212:213], v3 offset:32768
    ds_read_b64_tr_b16 a[176:177], v25 offset:16384
    s_add_u32 m0, s72, 4096
    ds_read_b64 v[214:215], v3 offset:49152
    v_add_u32 v3, s63, v2
    ds_read_b64 v[216:217], v3 offset:0
    ds_read_b64_tr_b16 a[178:179], v25 offset:18432
    ds_read_b64 v[218:219], v3 offset:16384
    s_add_u32 s69, s63, 57344
    ds_read_b64 v[220:221], v3 offset:32768
    ds_read_b64 v[222:223], v3 offset:49152
    ds_read_b64_tr_b16 a[180:181], v25 offset:20480
    v_add_u32 v3, s64, v2
    ds_read_b64 v[224:225], v3 offset:0
    buffer_load_dwordx4 v19, s[52:55], s69 offen offset:0 lds
    ds_read_b64_tr_b16 a[182:183], v25 offset:22528
    ds_read_b64 v[226:227], v3 offset:16384
    ds_read_b64 v[228:229], v3 offset:32768
    ds_read_b64 v[230:231], v3 offset:49152
    ds_read_b64_tr_b16 a[184:185], v25 offset:24576
    v_add_u32 v3, s65, v2
    buffer_load_dwordx4 v20, s[52:55], s69 offen offset:1024 lds
    ds_read_b64 v[232:233], v3 offset:0
    ds_read_b64 v[234:235], v3 offset:16384
    ds_read_b64_tr_b16 a[186:187], v25 offset:26624
    ds_read_b64 v[236:237], v3 offset:32768
    buffer_load_dwordx4 v21, s[52:55], s69 offen offset:2048 lds
    ds_read_b64 v[238:239], v3 offset:49152
    v_add_u32 v3, s66, v2
    ds_read_b64_tr_b16 a[188:189], v25 offset:28672
    ds_read_b64 v[240:241], v3 offset:0
    ds_read_b64 v[242:243], v3 offset:16384
    buffer_load_dwordx4 v22, s[52:55], s69 offen offset:3072 lds
    ds_read_b64 v[244:245], v3 offset:32768
    ds_read_b64_tr_b16 a[190:191], v25 offset:30720
    ds_read_b64 v[246:247], v3 offset:49152
    s_waitcnt vmcnt(8) lgkmcnt(1)
    s_barrier
    ds_read_b64_tr_b16 a[192:193], v26 offset:0
    s_add_u32 m0, s72, 32768
    ds_read_b64_tr_b16 a[194:195], v26 offset:2048
    s_add_u32 s69, s64, 0
    ds_read_b64_tr_b16 a[196:197], v26 offset:4096
    buffer_load_dwordx4 v19, s[52:55], s69 offen offset:0 lds
    ds_read_b64_tr_b16 a[198:199], v26 offset:6144
    ds_read_b64_tr_b16 a[200:201], v26 offset:8192
    buffer_load_dwordx4 v20, s[52:55], s69 offen offset:1024 lds
    ds_read_b64_tr_b16 a[202:203], v26 offset:10240
    buffer_load_dwordx4 v21, s[52:55], s69 offen offset:2048 lds
    ds_read_b64_tr_b16 a[204:205], v26 offset:12288
    buffer_load_dwordx4 v22, s[52:55], s69 offen offset:3072 lds
    ds_read_b64_tr_b16 a[206:207], v26 offset:14336
    ds_read_b64_tr_b16 a[208:209], v26 offset:16384
    s_add_u32 m0, s72, 36864
    ds_read_b64_tr_b16 a[210:211], v26 offset:18432
    s_add_u32 s69, s64, 57344
    ds_read_b64_tr_b16 a[212:213], v26 offset:20480
    buffer_load_dwordx4 v19, s[52:55], s69 offen offset:0 lds
    ds_read_b64_tr_b16 a[214:215], v26 offset:22528
    ds_read_b64_tr_b16 a[216:217], v26 offset:24576
    buffer_load_dwordx4 v20, s[52:55], s69 offen offset:1024 lds
    ds_read_b64_tr_b16 a[218:219], v26 offset:26624
    buffer_load_dwordx4 v21, s[52:55], s69 offen offset:2048 lds
    ds_read_b64_tr_b16 a[220:221], v26 offset:28672
    buffer_load_dwordx4 v22, s[52:55], s69 offen offset:3072 lds
    ds_read_b64_tr_b16 a[222:223], v26 offset:30720
    s_waitcnt lgkmcnt(0)
    s_barrier
    v_lshlrev_b32 v160, 16, v192
    v_and_b32 v161, 0xffff0000, v192
    v_lshlrev_b32 v162, 16, v193
    v_and_b32 v163, 0xffff0000, v193
    v_lshlrev_b32 v164, 16, v194
    v_and_b32 v165, 0xffff0000, v194
    v_lshlrev_b32 v166, 16, v195
    v_and_b32 v167, 0xffff0000, v195
    v_lshlrev_b32 v168, 16, v196
    v_and_b32 v169, 0xffff0000, v196
    v_lshlrev_b32 v170, 16, v197
    v_and_b32 v171, 0xffff0000, v197
    v_lshlrev_b32 v172, 16, v198
    v_and_b32 v173, 0xffff0000, v198
    v_lshlrev_b32 v174, 16, v199
    v_and_b32 v175, 0xffff0000, v199
    v_lshlrev_b32 v176, 16, v200
    v_and_b32 v177, 0xffff0000, v200
    v_lshlrev_b32 v178, 16, v201
    v_and_b32 v179, 0xffff0000, v201
    v_lshlrev_b32 v180, 16, v202
    v_and_b32 v181, 0xffff0000, v202
    v_lshlrev_b32 v182, 16, v203
    v_and_b32 v183, 0xffff0000, v203
    v_lshlrev_b32 v184, 16, v204
    v_and_b32 v185, 0xffff0000, v204
    v_lshlrev_b32 v186, 16, v205
    v_and_b32 v187, 0xffff0000, v205
    v_lshlrev_b32 v188, 16, v206
    v_and_b32 v189, 0xffff0000, v206
    v_lshlrev_b32 v190, 16, v207
    v_and_b32 v191, 0xffff0000, v207
    s_mov_b32 s0, 1
    s_branch L_hpage1
.p2align 12
L_hbody:
    s_mov_b32 s0, 0
    s_mov_b32 s79, 1048576
L_hp_poll:
    s_load_dwordx8 s[12:19], s[36:37], s89 glc
    s_sub_u32 s79, s79, 1
    s_waitcnt lgkmcnt(0)
    s_cbranch_scc1 L_hp_go
    s_xor_b32 s18, s18, s38
    s_xor_b32 s17, s17, s38
    s_xor_b32 s16, s38, s38
    s_or_b32 s18, s18, s17
    s_or_b32 s18, s18, s16
    s_cbranch_scc1 L_hp_poll
L_hp_go:
    s_lshr_b32 s76, s77, 1
    s_mul_i32 s76, s76, 14
    s_lshl2_add_u32 s78, s73, s3
    s_min_u32 s78, s78, 13
    s_add_u32 s76, s76, s78
    s_lshl_b32 s76, s76, 10
    s_add_u32 s76, s76, 65536
    buffer_load_dwordx4 v[252:255], v23, s[56:59], s76 offen sc1
    s_add_u32 m0, s72, 65536
    s_add_u32 s69, s71, 0
    buffer_load_dwordx4 v23, s[56:59], s69 offen offset:0 sc1 lds
    s_add_u32 m0, s72, 69632
    s_add_u32 s69, s71, 4096
    buffer_load_dwordx4 v23, s[56:59], s69 offen offset:0 sc1 lds
    s_add_u32 m0, s72, 65536
    s_add_u32 s69, s71, 0
    buffer_load_dwordx4 v23, s[56:59], s69 offen offset:1024 sc1 lds
    s_add_u32 m0, s72, 69632
    s_add_u32 s69, s71, 4096
    buffer_load_dwordx4 v23, s[56:59], s69 offen offset:1024 sc1 lds
    s_waitcnt vmcnt(2)
    s_add_u32 m0, s72, 65536
    s_add_u32 s69, s71, 0
    buffer_load_dwordx4 v23, s[56:59], s69 offen offset:2048 sc1 lds
    s_add_u32 m0, s72, 69632
    s_add_u32 s69, s71, 4096
    buffer_load_dwordx4 v23, s[56:59], s69 offen offset:2048 sc1 lds
    s_barrier
    ds_read_b128 a[0:3], v27 offset:0
    ds_read_b128 a[4:7], v27 offset:4096
    ds_read_b128 a[8:11], v27 offset:8192
    ds_read_b128 a[12:15], v27 offset:12288
    ds_read_b128 a[16:19], v27 offset:16384
    ds_read_b128 a[20:23], v27 offset:20480
    ds_read_b128 a[24:27], v27 offset:24576
    ds_read_b128 a[28:31], v27 offset:28672
    s_add_u32 m0, s72, 65536
    s_add_u32 s69, s71, 0
    buffer_load_dwordx4 v23, s[56:59], s69 offen offset:3072 sc1 lds
    s_add_u32 m0, s72, 69632
    s_add_u32 s69, s71, 4096
    buffer_load_dwordx4 v23, s[56:59], s69 offen offset:3072 sc1 lds
    s_waitcnt lgkmcnt(0)
    v_mfma_f32_16x16x32_bf16 v[160:163], a[128:131], a[0:3], v[160:163]
    s_waitcnt vmcnt(4)
    s_barrier
    v_mfma_f32_16x16x32_bf16 v[160:163], a[132:135], a[4:7], v[160:163]
    ds_read_b128 a[32:35], v27 offset:1024
    ds_read_b128 a[36:39], v27 offset:5120
    v_mfma_f32_16x16x32_bf16 v[160:163], a[136:139], a[8:11], v[160:163]
    ds_read_b128 a[40:43], v27 offset:9216
    ds_read_b128 a[44:47], v27 offset:13312
    v_mfma_f32_16x16x32_bf16 v[160:163], a[140:143], a[12:15], v[160:163]
    ds_read_b128 a[48:51], v27 offset:17408
    ds_read_b128 a[52:55], v27 offset:21504
    v_mfma_f32_16x16x32_bf16 v[160:163], a[144:147], a[16:19], v[160:163]
    ds_read_b128 a[56:59], v27 offset:25600
    ds_read_b128 a[60:63], v27 offset:29696
    v_mfma_f32_16x16x32_bf16 v[160:163], a[148:151], a[20:23], v[160:163]
    v_mfma_f32_16x16x32_bf16 v[160:163], a[152:155], a[24:27], v[160:163]
    v_mfma_f32_16x16x32_bf16 v[160:163], a[156:159], a[28:31], v[160:163]
    s_waitcnt lgkmcnt(0)
    v_mfma_f32_16x16x32_bf16 v[164:167], a[156:159], a[60:63], v[164:167]
    s_waitcnt vmcnt(2)
    s_barrier
    v_mfma_f32_16x16x32_bf16 v[164:167], a[152:155], a[56:59], v[164:167]
    ds_read_b128 a[64:67], v27 offset:2048
    ds_read_b128 a[68:71], v27 offset:6144
    v_mfma_f32_16x16x32_bf16 v[164:167], a[148:151], a[52:55], v[164:167]
    ds_read_b128 a[72:75], v27 offset:10240
    ds_read_b128 a[76:79], v27 offset:14336
    v_mfma_f32_16x16x32_bf16 v[164:167], a[144:147], a[48:51], v[164:167]
    ds_read_b128 a[80:83], v27 offset:18432
    ds_read_b128 a[84:87], v27 offset:22528
    v_mfma_f32_16x16x32_bf16 v[164:167], a[140:143], a[44:47], v[164:167]
    ds_read_b128 a[88:91], v27 offset:26624
    ds_read_b128 a[92:95], v27 offset:30720
    v_mfma_f32_16x16x32_bf16 v[164:167], a[136:139], a[40:43], v[164:167]
    v_mfma_f32_16x16x32_bf16 v[164:167], a[132:135], a[36:39], v[164:167]
    v_mfma_f32_16x16x32_bf16 v[164:167], a[128:131], a[32:35], v[164:167]
    s_waitcnt lgkmcnt(0)
    v_mfma_f32_16x16x32_bf16 v[168:171], a[128:131], a[64:67], v[168:171]
    s_waitcnt vmcnt(0)
    s_barrier
    v_mfma_f32_16x16x32_bf16 v[168:171], a[132:135], a[68:71], v[168:171]
    ds_read_b128 a[96:99], v27 offset:3072
    ds_read_b128 a[100:103], v27 offset:7168
    v_mfma_f32_16x16x32_bf16 v[168:171], a[136:139], a[72:75], v[168:171]
    ds_read_b128 a[104:107], v27 offset:11264
    ds_read_b128 a[108:111], v27 offset:15360
    v_mfma_f32_16x16x32_bf16 v[168:171], a[140:143], a[76:79], v[168:171]
    ds_read_b128 a[112:115], v27 offset:19456
    ds_read_b128 a[116:119], v27 offset:23552
    v_mfma_f32_16x16x32_bf16 v[168:171], a[144:147], a[80:83], v[168:171]
    ds_read_b128 a[120:123], v27 offset:27648
    ds_read_b128 a[124:127], v27 offset:31744
    v_mfma_f32_16x16x32_bf16 v[168:171], a[148:151], a[84:87], v[168:171]
    v_mfma_f32_16x16x32_bf16 v[168:171], a[152:155], a[88:91], v[168:171]
    v_mfma_f32_16x16x32_bf16 v[168:171], a[156:159], a[92:95], v[168:171]
    s_waitcnt lgkmcnt(0)
    v_mfma_f32_16x16x32_bf16 v[172:175], a[156:159], a[124:127], v[172:175]
    v_mfma_f32_16x16x32_bf16 v[172:175], a[152:155], a[120:123], v[172:175]
    v_mfma_f32_16x16x32_bf16 v[172:175], a[148:151], a[116:119], v[172:175]
    v_mfma_f32_16x16x32_bf16 v[172:175], a[144:147], a[112:115], v[172:175]
    v_mfma_f32_16x16x32_bf16 v[172:175], a[140:143], a[108:111], v[172:175]
    v_mfma_f32_16x16x32_bf16 v[172:175], a[136:139], a[104:107], v[172:175]
    v_mfma_f32_16x16x32_bf16 v[172:175], a[132:135], a[100:103], v[172:175]
    v_mfma_f32_16x16x32_bf16 v[172:175], a[128:131], a[96:99], v[172:175]
    s_barrier
    v_mfma_f32_16x16x32_bf16 v[176:179], a[160:163], a[0:3], v[176:179]
    s_add_u32 m0, s72, 65536
    v_mfma_f32_16x16x32_bf16 v[176:179], a[164:167], a[4:7], v[176:179]
    ds_read_b64_tr_b16 a[128:129], v24 offset:0
    v_mfma_f32_16x16x32_bf16 v[176:179], a[168:171], a[8:11], v[176:179]
    s_add_u32 s69, s65, 0
    ds_read_b64_tr_b16 a[130:131], v24 offset:2048
    v_mfma_f32_16x16x32_bf16 v[176:179], a[172:175], a[12:15], v[176:179]
    ds_read_b64_tr_b16 a[132:133], v24 offset:4096
    v_mfma_f32_16x16x32_bf16 v[176:179], a[176:179], a[16:19], v[176:179]
    buffer_load_dwordx4 v19, s[52:55], s69 offen offset:0 lds
    v_mfma_f32_16x16x32_bf16 v[176:179], a[180:183], a[20:23], v[176:179]
    ds_read_b64_tr_b16 a[134:135], v24 offset:6144
    v_cvt_pk_bf16_f32 v40, v160, v161
    v_mfma_f32_16x16x32_bf16 v[176:179], a[184:187], a[24:27], v[176:179]
    buffer_load_dwordx4 v20, s[52:55], s69 offen offset:1024 lds
    v_mfma_f32_16x16x32_bf16 v[176:179], a[188:191], a[28:31], v[176:179]
    ds_read_b64_tr_b16 a[136:137], v24 offset:8192
    ds_read_b64_tr_b16 a[138:139], v24 offset:10240
    v_mfma_f32_16x16x32_bf16 v[180:183], a[188:191], a[60:63], v[180:183]
    buffer_load_dwordx4 v21, s[52:55], s69 offen offset:2048 lds
    v_mfma_f32_16x16x32_bf16 v[180:183], a[184:187], a[56:59], v[180:183]
    ds_read_b64_tr_b16 a[140:141], v24 offset:12288
    v_cvt_pk_bf16_f32 v41, v162, v163
    v_mfma_f32_16x16x32_bf16 v[180:183], a[180:183], a[52:55], v[180:183]
    buffer_load_dwordx4 v22, s[52:55], s69 offen offset:3072 lds
    v_cvt_pk_bf16_f32 v42, v164, v165
    v_cvt_pk_bf16_f32 v43, v166, v167
    v_cvt_pk_bf16_f32 v44, v168, v169
    v_cvt_pk_bf16_f32 v45, v170, v171
    v_cvt_pk_bf16_f32 v46, v172, v173
    v_cvt_pk_bf16_f32 v47, v174, v175
    v_lshlrev_b32 v160, 16, v208
    v_mfma_f32_16x16x32_bf16 v[180:183], a[176:179], a[48:51], v[180:183]
    ds_read_b64_tr_b16 a[142:143], v24 offset:14336
    ds_read_b64_tr_b16 a[144:145], v24 offset:16384
    v_and_b32 v161, 0xffff0000, v208
    v_mfma_f32_16x16x32_bf16 v[180:183], a[172:175], a[44:47], v[180:183]
    ds_read_b64_tr_b16 a[146:147], v24 offset:18432
    v_lshlrev_b32 v162, 16, v209
    v_mfma_f32_16x16x32_bf16 v[180:183], a[168:171], a[40:43], v[180:183]
    s_add_u32 m0, s72, 69632
    v_and_b32 v163, 0xffff0000, v209
    v_mfma_f32_16x16x32_bf16 v[180:183], a[164:167], a[36:39], v[180:183]
    ds_read_b64_tr_b16 a[148:149], v24 offset:20480
    ds_write_b128 v28, v[40:43] offset:0
    v_lshlrev_b32 v164, 16, v210
    v_mfma_f32_16x16x32_bf16 v[180:183], a[160:163], a[32:35], v[180:183]
    s_add_u32 s69, s65, 57344
    ds_read_b64_tr_b16 a[150:151], v24 offset:22528
    v_mfma_f32_16x16x32_bf16 v[184:187], a[160:163], a[64:67], v[184:187]
    ds_read_b64_tr_b16 a[152:153], v24 offset:24576
    v_and_b32 v165, 0xffff0000, v210
    v_mfma_f32_16x16x32_bf16 v[184:187], a[164:167], a[68:71], v[184:187]
    buffer_load_dwordx4 v19, s[52:55], s69 offen offset:0 lds
    v_lshlrev_b32 v166, 16, v211
    v_mfma_f32_16x16x32_bf16 v[184:187], a[168:171], a[72:75], v[184:187]
    ds_read_b64_tr_b16 a[154:155], v24 offset:26624
    v_and_b32 v167, 0xffff0000, v211
    v_mfma_f32_16x16x32_bf16 v[184:187], a[172:175], a[76:79], v[184:187]
    buffer_load_dwordx4 v20, s[52:55], s69 offen offset:1024 lds
    v_lshlrev_b32 v168, 16, v212
    v_mfma_f32_16x16x32_bf16 v[184:187], a[176:179], a[80:83], v[184:187]
    ds_read_b64_tr_b16 a[156:157], v24 offset:28672
    ds_read_b64_tr_b16 a[158:159], v24 offset:30720
    v_and_b32 v169, 0xffff0000, v212
    v_mfma_f32_16x16x32_bf16 v[184:187], a[180:183], a[84:87], v[184:187]
    buffer_load_dwordx4 v21, s[52:55], s69 offen offset:2048 lds
    v_lshlrev_b32 v170, 16, v213
    v_mfma_f32_16x16x32_bf16 v[184:187], a[184:187], a[88:91], v[184:187]
    v_and_b32 v171, 0xffff0000, v213
    v_lshlrev_b32 v172, 16, v214
    v_mfma_f32_16x16x32_bf16 v[184:187], a[188:191], a[92:95], v[184:187]
    buffer_load_dwordx4 v22, s[52:55], s69 offen offset:3072 lds
    v_mfma_f32_16x16x32_bf16 v[188:191], a[188:191], a[124:127], v[188:191]
    ds_write_b128 v28, v[44:47] offset:1024
    v_and_b32 v173, 0xffff0000, v214
    v_mfma_f32_16x16x32_bf16 v[188:191], a[184:187], a[120:123], v[188:191]
    v_lshlrev_b32 v174, 16, v215
    v_and_b32 v175, 0xffff0000, v215
    v_mfma_f32_16x16x32_bf16 v[188:191], a[180:183], a[116:119], v[188:191]
    v_mfma_f32_16x16x32_bf16 v[188:191], a[176:179], a[112:115], v[188:191]
    v_mfma_f32_16x16x32_bf16 v[188:191], a[172:175], a[108:111], v[188:191]
    v_mfma_f32_16x16x32_bf16 v[188:191], a[168:171], a[104:107], v[188:191]
    v_mfma_f32_16x16x32_bf16 v[188:191], a[164:167], a[100:103], v[188:191]
    v_mfma_f32_16x16x32_bf16 v[188:191], a[160:163], a[96:99], v[188:191]
    s_waitcnt lgkmcnt(0)
    s_barrier
    v_mfma_f32_16x16x32_bf16 v[160:163], a[192:195], a[0:3], v[160:163]
    s_add_u32 m0, s72, 0
    ds_read_b128 v[48:51], v29 offset:0
    v_mfma_f32_16x16x32_bf16 v[160:163], a[196:199], a[4:7], v[160:163]
    s_add_u32 s69, s66, 0
    ds_read_b128 v[52:55], v29 offset:1024
    v_mfma_f32_16x16x32_bf16 v[160:163], a[200:203], a[8:11], v[160:163]
    ds_read_b64_tr_b16 a[160:161], v25 offset:0
    ds_read_b64_tr_b16 a[162:163], v25 offset:2048
    v_mfma_f32_16x16x32_bf16 v[160:163], a[204:207], a[12:15], v[160:163]
    buffer_load_dwordx4 v19, s[52:55], s69 offen offset:0 lds
    v_mfma_f32_16x16x32_bf16 v[160:163], a[208:211], a[16:19], v[160:163]
    buffer_load_dwordx4 v20, s[52:55], s69 offen offset:1024 lds
    v_mfma_f32_16x16x32_bf16 v[160:163], a[212:215], a[20:23], v[160:163]
    ds_read_b64_tr_b16 a[164:165], v25 offset:4096
    ds_read_b64_tr_b16 a[166:167], v25 offset:6144
    v_mfma_f32_16x16x32_bf16 v[160:163], a[216:219], a[24:27], v[160:163]
    buffer_load_dwordx4 v21, s[52:55], s69 offen offset:2048 lds
    v_mfma_f32_16x16x32_bf16 v[160:163], a[220:223], a[28:31], v[160:163]
    buffer_load_dwordx4 v22, s[52:55], s69 offen offset:3072 lds
    v_mfma_f32_16x16x32_bf16 v[164:167], a[220:223], a[60:63], v[164:167]
    ds_read_b64_tr_b16 a[168:169], v25 offset:8192
    ds_read_b64_tr_b16 a[170:171], v25 offset:10240
    v_mfma_f32_16x16x32_bf16 v[164:167], a[216:219], a[56:59], v[164:167]
    s_add_u32 m0, s72, 4096
    ds_read_b64_tr_b16 a[172:173], v25 offset:12288
    v_mfma_f32_16x16x32_bf16 v[164:167], a[212:215], a[52:55], v[164:167]
    s_add_u32 s69, s66, 57344
    ds_read_b64_tr_b16 a[174:175], v25 offset:14336
    v_cvt_pk_bf16_f32 v40, v176, v177
    v_cvt_pk_bf16_f32 v41, v178, v179
    v_cvt_pk_bf16_f32 v42, v180, v181
    v_cvt_pk_bf16_f32 v43, v182, v183
    v_cvt_pk_bf16_f32 v44, v184, v185
    v_cvt_pk_bf16_f32 v45, v186, v187
    v_cvt_pk_bf16_f32 v46, v188, v189
    v_cvt_pk_bf16_f32 v47, v190, v191
    v_lshlrev_b32 v176, 16, v216
    v_mfma_f32_16x16x32_bf16 v[164:167], a[208:211], a[48:51], v[164:167]
    ds_read_b64_tr_b16 a[176:177], v25 offset:16384
    v_and_b32 v177, 0xffff0000, v216
    v_mfma_f32_16x16x32_bf16 v[164:167], a[204:207], a[44:47], v[164:167]
    buffer_load_dwordx4 v19, s[52:55], s69 offen offset:0 lds
    v_lshlrev_b32 v178, 16, v217
    v_mfma_f32_16x16x32_bf16 v[164:167], a[200:203], a[40:43], v[164:167]
    buffer_load_dwordx4 v20, s[52:55], s69 offen offset:1024 lds
    v_and_b32 v179, 0xffff0000, v217
    v_mfma_f32_16x16x32_bf16 v[164:167], a[196:199], a[36:39], v[164:167]
    ds_read_b64_tr_b16 a[178:179], v25 offset:18432
    ds_read_b64_tr_b16 a[180:181], v25 offset:20480
    v_lshlrev_b32 v180, 16, v218
    v_mfma_f32_16x16x32_bf16 v[164:167], a[192:195], a[32:35], v[164:167]
    buffer_load_dwordx4 v21, s[52:55], s69 offen offset:2048 lds
    v_mfma_f32_16x16x32_bf16 v[168:171], a[192:195], a[64:67], v[168:171]
    buffer_load_dwordx4 v22, s[52:55], s69 offen offset:3072 lds
    ds_write_b128 v28, v[40:43] offset:8192
    v_and_b32 v181, 0xffff0000, v218
    v_mfma_f32_16x16x32_bf16 v[168:171], a[196:199], a[68:71], v[168:171]
    ds_read_b64_tr_b16 a[182:183], v25 offset:22528
    ds_read_b64_tr_b16 a[184:185], v25 offset:24576
    v_lshlrev_b32 v182, 16, v219
    v_mfma_f32_16x16x32_bf16 v[168:171], a[200:203], a[72:75], v[168:171]
    ds_read_b64_tr_b16 a[186:187], v25 offset:26624
    v_and_b32 v183, 0xffff0000, v219
    v_mfma_f32_16x16x32_bf16 v[168:171], a[204:207], a[76:79], v[168:171]
    ds_read_b64_tr_b16 a[188:189], v25 offset:28672
    v_lshlrev_b32 v184, 16, v220
    v_mfma_f32_16x16x32_bf16 v[168:171], a[208:211], a[80:83], v[168:171]
    ds_read_b64_tr_b16 a[190:191], v25 offset:30720
    s_lshl_b32 s75, s60, 6
    v_and_b32 v185, 0xffff0000, v220
    v_mfma_f32_16x16x32_bf16 v[168:171], a[212:215], a[84:87], v[168:171]
    s_add_u32 s75, s75, s74
    s_waitcnt lgkmcnt(15)
    v_lshlrev_b32 v186, 16, v221
    v_mfma_f32_16x16x32_bf16 v[168:171], a[216:219], a[88:91], v[168:171]
    buffer_store_dwordx4 v[48:51], v23, s[56:59], s75 offen offset:0 sc1
    v_mfma_f32_16x16x32_bf16 v[168:171], a[220:223], a[92:95], v[168:171]
    v_and_b32 v187, 0xffff0000, v221
    v_lshlrev_b32 v188, 16, v222
    v_mfma_f32_16x16x32_bf16 v[172:175], a[220:223], a[124:127], v[172:175]
    ds_write_b128 v28, v[44:47] offset:9216
    v_and_b32 v189, 0xffff0000, v222
    v_mfma_f32_16x16x32_bf16 v[172:175], a[216:219], a[120:123], v[172:175]
    v_lshlrev_b32 v190, 16, v223
    v_and_b32 v191, 0xffff0000, v223
    v_mfma_f32_16x16x32_bf16 v[172:175], a[212:215], a[116:119], v[172:175]
    v_mfma_f32_16x16x32_bf16 v[172:175], a[208:211], a[112:115], v[172:175]
    v_mfma_f32_16x16x32_bf16 v[172:175], a[204:207], a[108:111], v[172:175]
    v_mfma_f32_16x16x32_bf16 v[172:175], a[200:203], a[104:107], v[172:175]
    buffer_store_dwordx4 v[52:55], v23, s[56:59], s75 offen offset:1024 sc1
    v_mfma_f32_16x16x32_bf16 v[172:175], a[196:199], a[100:103], v[172:175]
    v_mfma_f32_16x16x32_bf16 v[172:175], a[192:195], a[96:99], v[172:175]
    s_waitcnt vmcnt(10) lgkmcnt(0)
    s_barrier
    v_mfma_f32_16x16x32_bf16 v[176:179], a[128:131], a[0:3], v[176:179]
    ds_read_b128 v[48:51], v29 offset:8192
    ds_read_b128 v[52:55], v29 offset:9216
    v_mfma_f32_16x16x32_bf16 v[176:179], a[132:135], a[4:7], v[176:179]
    ds_read_b64_tr_b16 a[192:193], v26 offset:0
    v_mfma_f32_16x16x32_bf16 v[176:179], a[136:139], a[8:11], v[176:179]
    ds_read_b64_tr_b16 a[194:195], v26 offset:2048
    v_mfma_f32_16x16x32_bf16 v[176:179], a[140:143], a[12:15], v[176:179]
    ds_read_b64_tr_b16 a[196:197], v26 offset:4096
    v_mfma_f32_16x16x32_bf16 v[176:179], a[144:147], a[16:19], v[176:179]
    ds_read_b64_tr_b16 a[198:199], v26 offset:6144
    v_mfma_f32_16x16x32_bf16 v[176:179], a[148:151], a[20:23], v[176:179]
    v_cvt_pk_bf16_f32 v40, v160, v161
    v_cvt_pk_bf16_f32 v41, v162, v163
    v_mfma_f32_16x16x32_bf16 v[176:179], a[152:155], a[24:27], v[176:179]
    ds_read_b64_tr_b16 a[200:201], v26 offset:8192
    v_cvt_pk_bf16_f32 v42, v164, v165
    v_mfma_f32_16x16x32_bf16 v[176:179], a[156:159], a[28:31], v[176:179]
    ds_read_b64_tr_b16 a[202:203], v26 offset:10240
    s_lshl_b32 s75, s61, 6
    v_mfma_f32_16x16x32_bf16 v[180:183], a[156:159], a[60:63], v[180:183]
    ds_read_b64_tr_b16 a[204:205], v26 offset:12288
    s_add_u32 s75, s75, s74
    v_mfma_f32_16x16x32_bf16 v[180:183], a[152:155], a[56:59], v[180:183]
    s_waitcnt lgkmcnt(7)
    v_cvt_pk_bf16_f32 v43, v166, v167
    v_mfma_f32_16x16x32_bf16 v[180:183], a[148:151], a[52:55], v[180:183]
    ds_read_b64_tr_b16 a[206:207], v26 offset:14336
    buffer_store_dwordx4 v[48:51], v23, s[56:59], s75 offen offset:0 sc1
    v_cvt_pk_bf16_f32 v44, v168, v169
    v_cvt_pk_bf16_f32 v45, v170, v171
    v_cvt_pk_bf16_f32 v46, v172, v173
    v_cvt_pk_bf16_f32 v47, v174, v175
    v_lshlrev_b32 v160, 16, v224
    v_mfma_f32_16x16x32_bf16 v[180:183], a[144:147], a[48:51], v[180:183]
    ds_read_b64_tr_b16 a[208:209], v26 offset:16384
    v_and_b32 v161, 0xffff0000, v224
    v_mfma_f32_16x16x32_bf16 v[180:183], a[140:143], a[44:47], v[180:183]
    ds_read_b64_tr_b16 a[210:211], v26 offset:18432
    v_lshlrev_b32 v162, 16, v225
    v_mfma_f32_16x16x32_bf16 v[180:183], a[136:139], a[40:43], v[180:183]
    v_and_b32 v163, 0xffff0000, v225
    v_lshlrev_b32 v164, 16, v226
    v_mfma_f32_16x16x32_bf16 v[180:183], a[132:135], a[36:39], v[180:183]
    ds_read_b64_tr_b16 a[212:213], v26 offset:20480
    ds_write_b128 v28, v[40:43] offset:0
    v_mfma_f32_16x16x32_bf16 v[180:183], a[128:131], a[32:35], v[180:183]
    ds_read_b64_tr_b16 a[214:215], v26 offset:22528
    v_and_b32 v165, 0xffff0000, v226
    v_mfma_f32_16x16x32_bf16 v[184:187], a[128:131], a[64:67], v[184:187]
    ds_read_b64_tr_b16 a[216:217], v26 offset:24576
    v_lshlrev_b32 v166, 16, v227
    v_mfma_f32_16x16x32_bf16 v[184:187], a[132:135], a[68:71], v[184:187]
    v_and_b32 v167, 0xffff0000, v227
    v_lshlrev_b32 v168, 16, v228
    v_mfma_f32_16x16x32_bf16 v[184:187], a[136:139], a[72:75], v[184:187]
    ds_read_b64_tr_b16 a[218:219], v26 offset:26624
    v_and_b32 v169, 0xffff0000, v228
    v_mfma_f32_16x16x32_bf16 v[184:187], a[140:143], a[76:79], v[184:187]
    ds_read_b64_tr_b16 a[220:221], v26 offset:28672
    v_lshlrev_b32 v170, 16, v229
    v_mfma_f32_16x16x32_bf16 v[184:187], a[144:147], a[80:83], v[184:187]
    ds_read_b64_tr_b16 a[222:223], v26 offset:30720
    v_and_b32 v171, 0xffff0000, v229
    v_mfma_f32_16x16x32_bf16 v[184:187], a[148:151], a[84:87], v[184:187]
    buffer_store_dwordx4 v[52:55], v23, s[56:59], s75 offen offset:1024 sc1
    v_mfma_f32_16x16x32_bf16 v[184:187], a[152:155], a[88:91], v[184:187]
    v_lshlrev_b32 v172, 16, v230
    v_and_b32 v173, 0xffff0000, v230
    v_mfma_f32_16x16x32_bf16 v[184:187], a[156:159], a[92:95], v[184:187]
    v_lshlrev_b32 v174, 16, v231
    v_and_b32 v175, 0xffff0000, v231
    v_mfma_f32_16x16x32_bf16 v[188:191], a[156:159], a[124:127], v[188:191]
    ds_write_b128 v28, v[44:47] offset:1024
    v_mfma_f32_16x16x32_bf16 v[188:191], a[152:155], a[120:123], v[188:191]
    v_mfma_f32_16x16x32_bf16 v[188:191], a[148:151], a[116:119], v[188:191]
    v_mfma_f32_16x16x32_bf16 v[188:191], a[144:147], a[112:115], v[188:191]
    v_mfma_f32_16x16x32_bf16 v[188:191], a[140:143], a[108:111], v[188:191]
    v_mfma_f32_16x16x32_bf16 v[188:191], a[136:139], a[104:107], v[188:191]
    v_mfma_f32_16x16x32_bf16 v[188:191], a[132:135], a[100:103], v[188:191]
    v_mfma_f32_16x16x32_bf16 v[188:191], a[128:131], a[96:99], v[188:191]
    s_waitcnt vmcnt(4) lgkmcnt(0)
    s_barrier
    v_mfma_f32_16x16x32_bf16 v[160:163], a[160:163], a[0:3], v[160:163]
    ds_read_b128 v[48:51], v29 offset:0
    ds_read_b128 v[52:55], v29 offset:1024
    v_mfma_f32_16x16x32_bf16 v[160:163], a[164:167], a[4:7], v[160:163]
    ds_read_b64_tr_b16 a[128:129], v24 offset:0
    v_mfma_f32_16x16x32_bf16 v[160:163], a[168:171], a[8:11], v[160:163]
    ds_read_b64_tr_b16 a[130:131], v24 offset:2048
    v_mfma_f32_16x16x32_bf16 v[160:163], a[172:175], a[12:15], v[160:163]
    ds_read_b64_tr_b16 a[132:133], v24 offset:4096
    v_mfma_f32_16x16x32_bf16 v[160:163], a[176:179], a[16:19], v[160:163]
    ds_read_b64_tr_b16 a[134:135], v24 offset:6144
    v_mfma_f32_16x16x32_bf16 v[160:163], a[180:183], a[20:23], v[160:163]
    v_cvt_pk_bf16_f32 v40, v176, v177
    v_cvt_pk_bf16_f32 v41, v178, v179
    v_mfma_f32_16x16x32_bf16 v[160:163], a[184:187], a[24:27], v[160:163]
    ds_read_b64_tr_b16 a[136:137], v24 offset:8192
    v_cvt_pk_bf16_f32 v42, v180, v181
    v_mfma_f32_16x16x32_bf16 v[160:163], a[188:191], a[28:31], v[160:163]
    ds_read_b64_tr_b16 a[138:139], v24 offset:10240
    s_lshl_b32 s75, s62, 6
    v_mfma_f32_16x16x32_bf16 v[164:167], a[188:191], a[60:63], v[164:167]
    ds_read_b64_tr_b16 a[140:141], v24 offset:12288
    s_add_u32 s75, s75, s74
    v_mfma_f32_16x16x32_bf16 v[164:167], a[184:187], a[56:59], v[164:167]
    s_waitcnt lgkmcnt(7)
    v_cvt_pk_bf16_f32 v43, v182, v183
    v_mfma_f32_16x16x32_bf16 v[164:167], a[180:183], a[52:55], v[164:167]
    ds_read_b64_tr_b16 a[142:143], v24 offset:14336
    buffer_store_dwordx4 v[48:51], v23, s[56:59], s75 offen offset:0 sc1
    v_cvt_pk_bf16_f32 v44, v184, v185
    v_cvt_pk_bf16_f32 v45, v186, v187
    v_cvt_pk_bf16_f32 v46, v188, v189
    v_cvt_pk_bf16_f32 v47, v190, v191
    v_lshlrev_b32 v176, 16, v232
    v_mfma_f32_16x16x32_bf16 v[164:167], a[176:179], a[48:51], v[164:167]
    ds_read_b64_tr_b16 a[144:145], v24 offset:16384
    v_and_b32 v177, 0xffff0000, v232
    v_mfma_f32_16x16x32_bf16 v[164:167], a[172:175], a[44:47], v[164:167]
    ds_read_b64_tr_b16 a[146:147], v24 offset:18432
    v_lshlrev_b32 v178, 16, v233
    v_mfma_f32_16x16x32_bf16 v[164:167], a[168:171], a[40:43], v[164:167]
    v_and_b32 v179, 0xffff0000, v233
    v_lshlrev_b32 v180, 16, v234
    v_mfma_f32_16x16x32_bf16 v[164:167], a[164:167], a[36:39], v[164:167]
    ds_read_b64_tr_b16 a[148:149], v24 offset:20480
    ds_write_b128 v28, v[40:43] offset:8192
    v_mfma_f32_16x16x32_bf16 v[164:167], a[160:163], a[32:35], v[164:167]
    ds_read_b64_tr_b16 a[150:151], v24 offset:22528
    v_and_b32 v181, 0xffff0000, v234
    v_mfma_f32_16x16x32_bf16 v[168:171], a[160:163], a[64:67], v[168:171]
    ds_read_b64_tr_b16 a[152:153], v24 offset:24576
    v_lshlrev_b32 v182, 16, v235
    v_mfma_f32_16x16x32_bf16 v[168:171], a[164:167], a[68:71], v[168:171]
    v_and_b32 v183, 0xffff0000, v235
    v_lshlrev_b32 v184, 16, v236
    v_mfma_f32_16x16x32_bf16 v[168:171], a[168:171], a[72:75], v[168:171]
    ds_read_b64_tr_b16 a[154:155], v24 offset:26624
    v_and_b32 v185, 0xffff0000, v236
    v_mfma_f32_16x16x32_bf16 v[168:171], a[172:175], a[76:79], v[168:171]
    ds_read_b64_tr_b16 a[156:157], v24 offset:28672
    v_lshlrev_b32 v186, 16, v237
    v_mfma_f32_16x16x32_bf16 v[168:171], a[176:179], a[80:83], v[168:171]
    ds_read_b64_tr_b16 a[158:159], v24 offset:30720
    v_and_b32 v187, 0xffff0000, v237
    v_mfma_f32_16x16x32_bf16 v[168:171], a[180:183], a[84:87], v[168:171]
    buffer_store_dwordx4 v[52:55], v23, s[56:59], s75 offen offset:1024 sc1
    v_mfma_f32_16x16x32_bf16 v[168:171], a[184:187], a[88:91], v[168:171]
    v_lshlrev_b32 v188, 16, v238
    v_and_b32 v189, 0xffff0000, v238
    v_mfma_f32_16x16x32_bf16 v[168:171], a[188:191], a[92:95], v[168:171]
    v_lshlrev_b32 v190, 16, v239
    v_and_b32 v191, 0xffff0000, v239
    v_mfma_f32_16x16x32_bf16 v[172:175], a[188:191], a[124:127], v[172:175]
    ds_write_b128 v28, v[44:47] offset:9216
    v_mfma_f32_16x16x32_bf16 v[172:175], a[184:187], a[120:123], v[172:175]
    v_mfma_f32_16x16x32_bf16 v[172:175], a[180:183], a[116:119], v[172:175]
    v_mfma_f32_16x16x32_bf16 v[172:175], a[176:179], a[112:115], v[172:175]
    v_mfma_f32_16x16x32_bf16 v[172:175], a[172:175], a[108:111], v[172:175]
    v_mfma_f32_16x16x32_bf16 v[172:175], a[168:171], a[104:107], v[172:175]
    v_mfma_f32_16x16x32_bf16 v[172:175], a[164:167], a[100:103], v[172:175]
    v_mfma_f32_16x16x32_bf16 v[172:175], a[160:163], a[96:99], v[172:175]
    s_waitcnt lgkmcnt(0)
    s_barrier
    v_mfma_f32_16x16x32_bf16 v[176:179], a[192:195], a[0:3], v[176:179]
    ds_read_b128 v[48:51], v29 offset:8192
    ds_read_b128 v[52:55], v29 offset:9216
    v_mfma_f32_16x16x32_bf16 v[176:179], a[196:199], a[4:7], v[176:179]
    v_mfma_f32_16x16x32_bf16 v[176:179], a[200:203], a[8:11], v[176:179]
    v_mfma_f32_16x16x32_bf16 v[176:179], a[204:207], a[12:15], v[176:179]
    v_mfma_f32_16x16x32_bf16 v[176:179], a[208:211], a[16:19], v[176:179]
    v_mfma_f32_16x16x32_bf16 v[176:179], a[212:215], a[20:23], v[176:179]
    v_cvt_pk_bf16_f32 v40, v160, v161
    v_cvt_pk_bf16_f32 v41, v162, v163
    v_mfma_f32_16x16x32_bf16 v[176:179], a[216:219], a[24:27], v[176:179]
    v_cvt_pk_bf16_f32 v42, v164, v165
    v_cvt_pk_bf16_f32 v43, v166, v167
    v_mfma_f32_16x16x32_bf16 v[176:179], a[220:223], a[28:31], v[176:179]
    s_lshl_b32 s75, s63, 6
    s_add_u32 s75, s75, s74
    v_mfma_f32_16x16x32_bf16 v[180:183], a[220:223], a[60:63], v[180:183]
    s_waitcnt lgkmcnt(0)
    v_cvt_pk_bf16_f32 v44, v168, v169
    v_mfma_f32_16x16x32_bf16 v[180:183], a[216:219], a[56:59], v[180:183]
    buffer_store_dwordx4 v[48:51], v23, s[56:59], s75 offen offset:0 sc1
    v_mfma_f32_16x16x32_bf16 v[180:183], a[212:215], a[52:55], v[180:183]
    v_cvt_pk_bf16_f32 v45, v170, v171
    v_cvt_pk_bf16_f32 v46, v172, v173
    v_cvt_pk_bf16_f32 v47, v174, v175
    v_lshlrev_b32 v160, 16, v240
    v_mfma_f32_16x16x32_bf16 v[180:183], a[208:211], a[48:51], v[180:183]
    v_and_b32 v161, 0xffff0000, v240
    v_lshlrev_b32 v162, 16, v241
    v_mfma_f32_16x16x32_bf16 v[180:183], a[204:207], a[44:47], v[180:183]
    v_and_b32 v163, 0xffff0000, v241
    v_lshlrev_b32 v164, 16, v242
    v_mfma_f32_16x16x32_bf16 v[180:183], a[200:203], a[40:43], v[180:183]
    v_and_b32 v165, 0xffff0000, v242
    v_lshlrev_b32 v166, 16, v243
    v_mfma_f32_16x16x32_bf16 v[180:183], a[196:199], a[36:39], v[180:183]
    ds_write_b128 v28, v[40:43] offset:0
    v_and_b32 v167, 0xffff0000, v243
    v_mfma_f32_16x16x32_bf16 v[180:183], a[192:195], a[32:35], v[180:183]
    v_lshlrev_b32 v168, 16, v244
    v_and_b32 v169, 0xffff0000, v244
    v_mfma_f32_16x16x32_bf16 v[184:187], a[192:195], a[64:67], v[184:187]
    v_lshlrev_b32 v170, 16, v245
    v_mfma_f32_16x16x32_bf16 v[184:187], a[196:199], a[68:71], v[184:187]
    v_mfma_f32_16x16x32_bf16 v[184:187], a[200:203], a[72:75], v[184:187]
    v_and_b32 v171, 0xffff0000, v245
    v_mfma_f32_16x16x32_bf16 v[184:187], a[204:207], a[76:79], v[184:187]
    buffer_store_dwordx4 v[52:55], v23, s[56:59], s75 offen offset:1024 sc1
    v_mfma_f32_16x16x32_bf16 v[184:187], a[208:211], a[80:83], v[184:187]
    v_lshlrev_b32 v172, 16, v246
    v_and_b32 v173, 0xffff0000, v246
    v_mfma_f32_16x16x32_bf16 v[184:187], a[212:215], a[84:87], v[184:187]
    v_lshlrev_b32 v174, 16, v247
    v_mfma_f32_16x16x32_bf16 v[184:187], a[216:219], a[88:91], v[184:187]
    v_and_b32 v175, 0xffff0000, v247
    v_mfma_f32_16x16x32_bf16 v[184:187], a[220:223], a[92:95], v[184:187]
    v_mfma_f32_16x16x32_bf16 v[188:191], a[220:223], a[124:127], v[188:191]
    ds_write_b128 v28, v[44:47] offset:1024
    v_mfma_f32_16x16x32_bf16 v[188:191], a[216:219], a[120:123], v[188:191]
    v_mfma_f32_16x16x32_bf16 v[188:191], a[212:215], a[116:119], v[188:191]
    v_mfma_f32_16x16x32_bf16 v[188:191], a[208:211], a[112:115], v[188:191]
    v_mfma_f32_16x16x32_bf16 v[188:191], a[204:207], a[108:111], v[188:191]
    v_mfma_f32_16x16x32_bf16 v[188:191], a[200:203], a[104:107], v[188:191]
    v_mfma_f32_16x16x32_bf16 v[188:191], a[196:199], a[100:103], v[188:191]
    v_mfma_f32_16x16x32_bf16 v[188:191], a[192:195], a[96:99], v[188:191]
    s_waitcnt lgkmcnt(0)
    s_barrier
    v_mfma_f32_16x16x32_bf16 v[160:163], a[128:131], a[0:3], v[160:163]
    ds_read_b128 v[48:51], v29 offset:0
    ds_read_b128 v[52:55], v29 offset:1024
    v_mfma_f32_16x16x32_bf16 v[160:163], a[132:135], a[4:7], v[160:163]
    v_mfma_f32_16x16x32_bf16 v[160:163], a[136:139], a[8:11], v[160:163]
    v_mfma_f32_16x16x32_bf16 v[160:163], a[140:143], a[12:15], v[160:163]
    v_mfma_f32_16x16x32_bf16 v[160:163], a[144:147], a[16:19], v[160:163]
    v_mfma_f32_16x16x32_bf16 v[160:163], a[148:151], a[20:23], v[160:163]
    v_cvt_pk_bf16_f32 v40, v176, v177
    v_cvt_pk_bf16_f32 v41, v178, v179
    v_mfma_f32_16x16x32_bf16 v[160:163], a[152:155], a[24:27], v[160:163]
    v_cvt_pk_bf16_f32 v42, v180, v181
    v_cvt_pk_bf16_f32 v43, v182, v183
    v_mfma_f32_16x16x32_bf16 v[160:163], a[156:159], a[28:31], v[160:163]
    s_lshl_b32 s75, s64, 6
    s_add_u32 s75, s75, s74
    v_mfma_f32_16x16x32_bf16 v[164:167], a[156:159], a[60:63], v[164:167]
    s_waitcnt lgkmcnt(0)
    v_cvt_pk_bf16_f32 v44, v184, v185
    v_mfma_f32_16x16x32_bf16 v[164:167], a[152:155], a[56:59], v[164:167]
    buffer_store_dwordx4 v[48:51], v23, s[56:59], s75 offen offset:0 sc1
    v_mfma_f32_16x16x32_bf16 v[164:167], a[148:151], a[52:55], v[164:167]
    v_cvt_pk_bf16_f32 v45, v186, v187
    v_cvt_pk_bf16_f32 v46, v188, v189
    v_mfma_f32_16x16x32_bf16 v[164:167], a[144:147], a[48:51], v[164:167]
    v_cvt_pk_bf16_f32 v47, v190, v191
    v_mfma_f32_16x16x32_bf16 v[164:167], a[140:143], a[44:47], v[164:167]
L_hpage1:
    s_cmp_eq_u32 s0, 1
    s_cbranch_scc1 L_hbody
    v_mfma_f32_16x16x32_bf16 v[164:167], a[136:139], a[40:43], v[164:167]
    v_mfma_f32_16x16x32_bf16 v[164:167], a[132:135], a[36:39], v[164:167]
    ds_write_b128 v28, v[40:43] offset:8192
    v_mfma_f32_16x16x32_bf16 v[164:167], a[128:131], a[32:35], v[164:167]
    v_mfma_f32_16x16x32_bf16 v[168:171], a[128:131], a[64:67], v[168:171]
    v_mfma_f32_16x16x32_bf16 v[168:171], a[132:135], a[68:71], v[168:171]
    v_mfma_f32_16x16x32_bf16 v[168:171], a[136:139], a[72:75], v[168:171]
    v_mfma_f32_16x16x32_bf16 v[168:171], a[140:143], a[76:79], v[168:171]
    buffer_store_dwordx4 v[52:55], v23, s[56:59], s75 offen offset:1024 sc1
    v_mfma_f32_16x16x32_bf16 v[168:171], a[144:147], a[80:83], v[168:171]
    v_mfma_f32_16x16x32_bf16 v[168:171], a[148:151], a[84:87], v[168:171]
    v_mfma_f32_16x16x32_bf16 v[168:171], a[152:155], a[88:91], v[168:171]
    v_mfma_f32_16x16x32_bf16 v[168:171], a[156:159], a[92:95], v[168:171]
    v_mfma_f32_16x16x32_bf16 v[172:175], a[156:159], a[124:127], v[172:175]
    ds_write_b128 v28, v[44:47] offset:9216
    v_mfma_f32_16x16x32_bf16 v[172:175], a[152:155], a[120:123], v[172:175]
    v_mfma_f32_16x16x32_bf16 v[172:175], a[148:151], a[116:119], v[172:175]
    v_mfma_f32_16x16x32_bf16 v[172:175], a[144:147], a[112:115], v[172:175]
    v_mfma_f32_16x16x32_bf16 v[172:175], a[140:143], a[108:111], v[172:175]
    v_mfma_f32_16x16x32_bf16 v[172:175], a[136:139], a[104:107], v[172:175]
    v_mfma_f32_16x16x32_bf16 v[172:175], a[132:135], a[100:103], v[172:175]
    v_mfma_f32_16x16x32_bf16 v[172:175], a[128:131], a[96:99], v[172:175]
    s_waitcnt lgkmcnt(0)
    s_barrier
    ds_read_b128 v[48:51], v29 offset:8192
    ds_read_b128 v[52:55], v29 offset:9216
    v_cvt_pk_bf16_f32 v40, v160, v161
    v_cvt_pk_bf16_f32 v41, v162, v163
    v_cvt_pk_bf16_f32 v42, v164, v165
    v_cvt_pk_bf16_f32 v43, v166, v167
    v_cvt_pk_bf16_f32 v44, v168, v169
    v_cvt_pk_bf16_f32 v45, v170, v171
    v_cvt_pk_bf16_f32 v46, v172, v173
    v_cvt_pk_bf16_f32 v47, v174, v175
    ds_write_b128 v28, v[40:43] offset:0
    ds_write_b128 v28, v[44:47] offset:1024
    s_lshl_b32 s75, s65, 6
    s_add_u32 s75, s75, s74
    s_waitcnt lgkmcnt(2)
    buffer_store_dwordx4 v[48:51], v23, s[56:59], s75 offen offset:0 sc1
    buffer_store_dwordx4 v[52:55], v23, s[56:59], s75 offen offset:1024 sc1
    s_waitcnt lgkmcnt(0)
    s_barrier
    ds_read_b128 v[48:51], v29 offset:0
    ds_read_b128 v[52:55], v29 offset:1024
    s_lshl_b32 s75, s66, 6
    s_add_u32 s75, s75, s74
    s_waitcnt lgkmcnt(0)
    buffer_store_dwordx4 v[48:51], v23, s[56:59], s75 offen offset:0 sc1
    buffer_store_dwordx4 v[52:55], v23, s[56:59], s75 offen offset:1024 sc1
    s_waitcnt vmcnt(0)
    s_atomic_swap s38, s[36:37], s89 offset:608
    s_mov_b32 s66, s83
    s_cmp_eq_u32 s66, 31
    s_cbranch_scc0 L_end
    v_lshlrev_b32 v4, 8, v0
    v_add_u32 v4, 65540, v4
    v_subrev_u32 v5, 224, v0
    v_lshlrev_b32 v5, 9, v5
    v_add_u32 v5, 49408, v5
    v_cmp_le_u32 vcc, 224, v0
    s_nop 1
    v_cndmask_b32 v4, v4, v5, vcc
    s_mov_b32 s72, 1048576
L_keep:
    buffer_load_dword v5, v4, s[56:59], 0 offen sc1
    s_sub_u32 s72, s72, 1
    s_waitcnt vmcnt(0)
    s_cbranch_scc1 L_keep_done
    v_cmp_ne_u32 vcc, v5, v37
    s_nop 1
    s_cbranch_vccnz L_keep
L_keep_done:
    s_barrier
    v_min_u32 v4, 1, v0
    v_lshlrev_b32 v4, 31, v4
    buffer_store_dword v37, v4, s[56:59], 0 offen sc1
L_end:
    s_endpgm

L_code_end:
.p2align 12
.fill 1024, 4, 0xbf800000
.section .rodata,"a"
.p2align 6
.amdhsa_kernel gated_mix__ssm_conv_s5__glu_gated_bilinear__prompt_kernel
  .amdhsa_next_free_vgpr 512
  .amdhsa_next_free_sgpr 102
  .amdhsa_accum_offset 256
  .amdhsa_group_segment_fixed_size 0
  .amdhsa_kernarg_size 136
  .amdhsa_user_sgpr_count 2
  .amdhsa_user_sgpr_kernarg_segment_ptr 1
  .amdhsa_system_sgpr_workgroup_id_x 1
.end_amdhsa_kernel
```
